```python
import torch

def _softmax(x, axis=-1):
    return torch.softmax(x, dim=axis)
def _gelu(x):
    return torch.nn.functional.gelu(x, approximate="tanh")
def _silu(x):
    return torch.nn.functional.silu(x)
def _sigmoid(x):
    return torch.sigmoid(x)
def _layernorm(x, axis=-1, eps=1e-5):
    m = x.mean(dim=axis, keepdim=True)
    v = x.var(dim=axis, keepdim=True, unbiased=False)
    return (x - m) / torch.sqrt(v + eps)
def _scatter_add(tgt, idx, src, axis=0):
    return tgt.clone().index_add_(axis, idx, src)
def _segment_sum(src, seg, n):
    out = torch.zeros((n,) + src.shape[1:], dtype=src.dtype)
    return out.index_add_(0, seg, src)
def _pad(x, pw):
    flat = tuple(v for pair in reversed(pw) for v in pair)
    return torch.nn.functional.pad(x, flat)

kernel_name = 'standalone__layernorm_linear__sampling'

def setup_inputs():

    _w = (lambda a: (lambda t: t.to(torch.bfloat16) if t.is_floating_point() else t)(torch.as_tensor(a)))
    B, S, D = 1024, 8, 640
    return {
        "x": _w((lambda *s: torch.randn(*s, dtype=torch.bfloat16) * 0.05)(B, S, D)),
        "g": _w((lambda *s: torch.randn(*s, dtype=torch.bfloat16) * 0.05)(D) + 1.0),
        "b": _w((lambda *s: torch.randn(*s, dtype=torch.bfloat16) * 0.4)(D)),
        "w": _w((lambda *s: torch.randn(*s, dtype=torch.bfloat16) * 0.05)(D, D)),
    }

def reference(x, g, b, w):
    return (_layernorm(x, axis=-1) * g + b) @ w
```

```asm
; @launch grid=(256,1,1) block=(512,1,1) lds=163840
.amdgcn_target "amdgcn-amd-amdhsa--gfx950"
.text
.globl standalone__layernorm_linear__sampling_kernel
.p2align 8
.type standalone__layernorm_linear__sampling_kernel,@function
standalone__layernorm_linear__sampling_kernel:
    s_cmp_ge_u32 s2, 256
    s_cbranch_scc1 L_end
    s_load_dwordx4 s[32:35], s[0:1], 0
    s_load_dwordx4 s[36:39], s[0:1], 16
    s_load_dwordx2 s[40:41], s[0:1], 32
    s_and_b32 s29, s2, 7
    s_lshr_b32 s30, s2, 3
    s_and_b32 s25, s30, 3
    s_lshr_b32 s30, s30, 2
    s_lshl_b32 s24, s29, 3
    s_add_u32 s24, s24, s30
    v_mov_b32 v249, v0
    v_and_b32 v232, 63, v0
    v_lshrrev_b32 v234, 6, v0
    s_nop 0
    v_readfirstlane_b32 s26, v234
    s_nop 3
    s_and_b32 s28, s26, 3
    s_lshr_b32 s27, s26, 2
    s_waitcnt lgkmcnt(0)
    s_mov_b32 s4, s32
    s_and_b32 s5, s33, 0xffff
    s_mov_b32 s6, 10485760
    s_mov_b32 s7, 0x00020000
    s_mov_b32 s16, s34
    s_and_b32 s17, s35, 0xffff
    s_mov_b32 s18, 1280
    s_mov_b32 s19, 0x00020000
    s_mov_b32 s20, s36
    s_and_b32 s21, s37, 0xffff
    s_mov_b32 s22, 1280
    s_mov_b32 s23, 0x00020000
    s_mov_b32 s8, s38
    s_and_b32 s9, s39, 0xffff
    s_mov_b32 s10, 819200
    s_mov_b32 s11, 0x00020000
    s_mov_b32 s12, s40
    s_and_b32 s13, s41, 0xffff
    s_mov_b32 s14, 10485760
    s_mov_b32 s15, 0x00020000
    v_lshrrev_b32 v233, 5, v232
    s_lshl_b32 s29, s24, 7
    s_lshl_b32 s30, s26, 4
    s_add_u32 s29, s29, s30
    s_mul_i32 s47, s29, 1280
    s_mov_b32 s44, 52429
    s_mul_i32 s46, s26, 20480
    v_add_u32 v234, 0, v232
    v_mul_lo_u32 v235, v234, s44
    v_lshrrev_b32 v235, 22, v235
    v_mul_u32_u24 v236, 80, v235
    v_sub_u32 v236, v234, v236
    v_xor_b32 v236, v236, v235
    v_mul_u32_u24 v235, 1280, v235
    v_lshl_add_u32 v235, v236, 4, v235
    s_add_u32 s48, s46, 0
    s_mov_b32 m0, s48
    s_nop 0
    buffer_load_dwordx4 v235, s[4:7], s47 offen lds
    v_add_u32 v234, 64, v232
    v_mul_lo_u32 v235, v234, s44
    v_lshrrev_b32 v235, 22, v235
    v_mul_u32_u24 v236, 80, v235
    v_sub_u32 v236, v234, v236
    v_xor_b32 v236, v236, v235
    v_mul_u32_u24 v235, 1280, v235
    v_lshl_add_u32 v235, v236, 4, v235
    s_add_u32 s48, s46, 1024
    s_mov_b32 m0, s48
    s_nop 0
    buffer_load_dwordx4 v235, s[4:7], s47 offen lds
    v_add_u32 v234, 128, v232
    v_mul_lo_u32 v235, v234, s44
    v_lshrrev_b32 v235, 22, v235
    v_mul_u32_u24 v236, 80, v235
    v_sub_u32 v236, v234, v236
    v_xor_b32 v236, v236, v235
    v_mul_u32_u24 v235, 1280, v235
    v_lshl_add_u32 v235, v236, 4, v235
    s_add_u32 s48, s46, 2048
    s_mov_b32 m0, s48
    s_nop 0
    buffer_load_dwordx4 v235, s[4:7], s47 offen lds
    v_add_u32 v234, 192, v232
    v_mul_lo_u32 v235, v234, s44
    v_lshrrev_b32 v235, 22, v235
    v_mul_u32_u24 v236, 80, v235
    v_sub_u32 v236, v234, v236
    v_xor_b32 v236, v236, v235
    v_mul_u32_u24 v235, 1280, v235
    v_lshl_add_u32 v235, v236, 4, v235
    s_add_u32 s48, s46, 3072
    s_mov_b32 m0, s48
    s_nop 0
    buffer_load_dwordx4 v235, s[4:7], s47 offen lds
    v_add_u32 v234, 256, v232
    v_mul_lo_u32 v235, v234, s44
    v_lshrrev_b32 v235, 22, v235
    v_mul_u32_u24 v236, 80, v235
    v_sub_u32 v236, v234, v236
    v_xor_b32 v236, v236, v235
    v_mul_u32_u24 v235, 1280, v235
    v_lshl_add_u32 v235, v236, 4, v235
    s_add_u32 s48, s46, 4096
    s_mov_b32 m0, s48
    s_nop 0
    buffer_load_dwordx4 v235, s[4:7], s47 offen lds
    v_add_u32 v234, 320, v232
    v_mul_lo_u32 v235, v234, s44
    v_lshrrev_b32 v235, 22, v235
    v_mul_u32_u24 v236, 80, v235
    v_sub_u32 v236, v234, v236
    v_xor_b32 v236, v236, v235
    v_mul_u32_u24 v235, 1280, v235
    v_lshl_add_u32 v235, v236, 4, v235
    s_add_u32 s48, s46, 5120
    s_mov_b32 m0, s48
    s_nop 0
    buffer_load_dwordx4 v235, s[4:7], s47 offen lds
    v_add_u32 v234, 384, v232
    v_mul_lo_u32 v235, v234, s44
    v_lshrrev_b32 v235, 22, v235
    v_mul_u32_u24 v236, 80, v235
    v_sub_u32 v236, v234, v236
    v_xor_b32 v236, v236, v235
    v_mul_u32_u24 v235, 1280, v235
    v_lshl_add_u32 v235, v236, 4, v235
    s_add_u32 s48, s46, 6144
    s_mov_b32 m0, s48
    s_nop 0
    buffer_load_dwordx4 v235, s[4:7], s47 offen lds
    v_add_u32 v234, 448, v232
    v_mul_lo_u32 v235, v234, s44
    v_lshrrev_b32 v235, 22, v235
    v_mul_u32_u24 v236, 80, v235
    v_sub_u32 v236, v234, v236
    v_xor_b32 v236, v236, v235
    v_mul_u32_u24 v235, 1280, v235
    v_lshl_add_u32 v235, v236, 4, v235
    s_add_u32 s48, s46, 7168
    s_mov_b32 m0, s48
    s_nop 0
    buffer_load_dwordx4 v235, s[4:7], s47 offen lds
    v_add_u32 v234, 512, v232
    v_mul_lo_u32 v235, v234, s44
    v_lshrrev_b32 v235, 22, v235
    v_mul_u32_u24 v236, 80, v235
    v_sub_u32 v236, v234, v236
    v_xor_b32 v236, v236, v235
    v_mul_u32_u24 v235, 1280, v235
    v_lshl_add_u32 v235, v236, 4, v235
    s_add_u32 s48, s46, 8192
    s_mov_b32 m0, s48
    s_nop 0
    buffer_load_dwordx4 v235, s[4:7], s47 offen lds
    v_add_u32 v234, 576, v232
    v_mul_lo_u32 v235, v234, s44
    v_lshrrev_b32 v235, 22, v235
    v_mul_u32_u24 v236, 80, v235
    v_sub_u32 v236, v234, v236
    v_xor_b32 v236, v236, v235
    v_mul_u32_u24 v235, 1280, v235
    v_lshl_add_u32 v235, v236, 4, v235
    s_add_u32 s48, s46, 9216
    s_mov_b32 m0, s48
    s_nop 0
    buffer_load_dwordx4 v235, s[4:7], s47 offen lds
    v_add_u32 v234, 640, v232
    v_mul_lo_u32 v235, v234, s44
    v_lshrrev_b32 v235, 22, v235
    v_mul_u32_u24 v236, 80, v235
    v_sub_u32 v236, v234, v236
    v_xor_b32 v236, v236, v235
    v_mul_u32_u24 v235, 1280, v235
    v_lshl_add_u32 v235, v236, 4, v235
    s_add_u32 s48, s46, 10240
    s_mov_b32 m0, s48
    s_nop 0
    buffer_load_dwordx4 v235, s[4:7], s47 offen lds
    v_add_u32 v234, 704, v232
    v_mul_lo_u32 v235, v234, s44
    v_lshrrev_b32 v235, 22, v235
    v_mul_u32_u24 v236, 80, v235
    v_sub_u32 v236, v234, v236
    v_xor_b32 v236, v236, v235
    v_mul_u32_u24 v235, 1280, v235
    v_lshl_add_u32 v235, v236, 4, v235
    s_add_u32 s48, s46, 11264
    s_mov_b32 m0, s48
    s_nop 0
    buffer_load_dwordx4 v235, s[4:7], s47 offen lds
    v_add_u32 v234, 768, v232
    v_mul_lo_u32 v235, v234, s44
    v_lshrrev_b32 v235, 22, v235
    v_mul_u32_u24 v236, 80, v235
    v_sub_u32 v236, v234, v236
    v_xor_b32 v236, v236, v235
    v_mul_u32_u24 v235, 1280, v235
    v_lshl_add_u32 v235, v236, 4, v235
    s_add_u32 s48, s46, 12288
    s_mov_b32 m0, s48
    s_nop 0
    buffer_load_dwordx4 v235, s[4:7], s47 offen lds
    v_add_u32 v234, 832, v232
    v_mul_lo_u32 v235, v234, s44
    v_lshrrev_b32 v235, 22, v235
    v_mul_u32_u24 v236, 80, v235
    v_sub_u32 v236, v234, v236
    v_xor_b32 v236, v236, v235
    v_mul_u32_u24 v235, 1280, v235
    v_lshl_add_u32 v235, v236, 4, v235
    s_add_u32 s48, s46, 13312
    s_mov_b32 m0, s48
    s_nop 0
    buffer_load_dwordx4 v235, s[4:7], s47 offen lds
    v_add_u32 v234, 896, v232
    v_mul_lo_u32 v235, v234, s44
    v_lshrrev_b32 v235, 22, v235
    v_mul_u32_u24 v236, 80, v235
    v_sub_u32 v236, v234, v236
    v_xor_b32 v236, v236, v235
    v_mul_u32_u24 v235, 1280, v235
    v_lshl_add_u32 v235, v236, 4, v235
    s_add_u32 s48, s46, 14336
    s_mov_b32 m0, s48
    s_nop 0
    buffer_load_dwordx4 v235, s[4:7], s47 offen lds
    v_add_u32 v234, 960, v232
    v_mul_lo_u32 v235, v234, s44
    v_lshrrev_b32 v235, 22, v235
    v_mul_u32_u24 v236, 80, v235
    v_sub_u32 v236, v234, v236
    v_xor_b32 v236, v236, v235
    v_mul_u32_u24 v235, 1280, v235
    v_lshl_add_u32 v235, v236, 4, v235
    s_add_u32 s48, s46, 15360
    s_mov_b32 m0, s48
    s_nop 0
    buffer_load_dwordx4 v235, s[4:7], s47 offen lds
    v_add_u32 v234, 1024, v232
    v_mul_lo_u32 v235, v234, s44
    v_lshrrev_b32 v235, 22, v235
    v_mul_u32_u24 v236, 80, v235
    v_sub_u32 v236, v234, v236
    v_xor_b32 v236, v236, v235
    v_mul_u32_u24 v235, 1280, v235
    v_lshl_add_u32 v235, v236, 4, v235
    s_add_u32 s48, s46, 16384
    s_mov_b32 m0, s48
    s_nop 0
    buffer_load_dwordx4 v235, s[4:7], s47 offen lds
    v_add_u32 v234, 1088, v232
    v_mul_lo_u32 v235, v234, s44
    v_lshrrev_b32 v235, 22, v235
    v_mul_u32_u24 v236, 80, v235
    v_sub_u32 v236, v234, v236
    v_xor_b32 v236, v236, v235
    v_mul_u32_u24 v235, 1280, v235
    v_lshl_add_u32 v235, v236, 4, v235
    s_add_u32 s48, s46, 17408
    s_mov_b32 m0, s48
    s_nop 0
    buffer_load_dwordx4 v235, s[4:7], s47 offen lds
    v_add_u32 v234, 1152, v232
    v_mul_lo_u32 v235, v234, s44
    v_lshrrev_b32 v235, 22, v235
    v_mul_u32_u24 v236, 80, v235
    v_sub_u32 v236, v234, v236
    v_xor_b32 v236, v236, v235
    v_mul_u32_u24 v235, 1280, v235
    v_lshl_add_u32 v235, v236, 4, v235
    s_add_u32 s48, s46, 18432
    s_mov_b32 m0, s48
    s_nop 0
    buffer_load_dwordx4 v235, s[4:7], s47 offen lds
    v_add_u32 v234, 1216, v232
    v_mul_lo_u32 v235, v234, s44
    v_lshrrev_b32 v235, 22, v235
    v_mul_u32_u24 v236, 80, v235
    v_sub_u32 v236, v234, v236
    v_xor_b32 v236, v236, v235
    v_mul_u32_u24 v235, 1280, v235
    v_lshl_add_u32 v235, v236, 4, v235
    s_add_u32 s48, s46, 19456
    s_mov_b32 m0, s48
    s_nop 0
    buffer_load_dwordx4 v235, s[4:7], s47 offen lds
    v_lshlrev_b32 v235, 2, v249
    buffer_load_dword v254, v235, s[16:19], 0 offen
    buffer_load_dword v255, v235, s[20:23], 0 offen
    s_mul_i32 s29, s26, 320
    s_mul_i32 s30, s25, 320
    s_movk_i32 s44, 3277
    s_movk_i32 s45, 1280
    v_add_u32 v234, s29, v232
    v_mul_lo_u32 v235, v234, s44
    v_lshrrev_b32 v235, 16, v235
    v_mul_u32_u24 v236, 20, v235
    v_sub_u32 v236, v234, v236
    v_lshrrev_b32 v237, 6, v235
    v_mul_u32_u24 v237, 320, v237
    v_and_b32 v235, 63, v235
    v_add_u32 v235, v235, v237
    v_mul_lo_u32 v235, v235, s45
    v_lshl_add_u32 v235, v236, 4, v235
    v_add_u32 v238, s30, v235
    v_add_u32 v234, s29, v232
    v_add_u32 v234, 64, v234
    v_mul_lo_u32 v235, v234, s44
    v_lshrrev_b32 v235, 16, v235
    v_mul_u32_u24 v236, 20, v235
    v_sub_u32 v236, v234, v236
    v_lshrrev_b32 v237, 6, v235
    v_mul_u32_u24 v237, 320, v237
    v_and_b32 v235, 63, v235
    v_add_u32 v235, v235, v237
    v_mul_lo_u32 v235, v235, s45
    v_lshl_add_u32 v235, v236, 4, v235
    v_add_u32 v239, s30, v235
    v_add_u32 v234, s29, v232
    v_add_u32 v234, 128, v234
    v_mul_lo_u32 v235, v234, s44
    v_lshrrev_b32 v235, 16, v235
    v_mul_u32_u24 v236, 20, v235
    v_sub_u32 v236, v234, v236
    v_lshrrev_b32 v237, 6, v235
    v_mul_u32_u24 v237, 320, v237
    v_and_b32 v235, 63, v235
    v_add_u32 v235, v235, v237
    v_mul_lo_u32 v235, v235, s45
    v_lshl_add_u32 v235, v236, 4, v235
    v_add_u32 v240, s30, v235
    v_add_u32 v234, s29, v232
    v_add_u32 v234, 192, v234
    v_mul_lo_u32 v235, v234, s44
    v_lshrrev_b32 v235, 16, v235
    v_mul_u32_u24 v236, 20, v235
    v_sub_u32 v236, v234, v236
    v_lshrrev_b32 v237, 6, v235
    v_mul_u32_u24 v237, 320, v237
    v_and_b32 v235, 63, v235
    v_add_u32 v235, v235, v237
    v_mul_lo_u32 v235, v235, s45
    v_lshl_add_u32 v235, v236, 4, v235
    v_add_u32 v241, s30, v235
    v_add_u32 v234, s29, v232
    v_add_u32 v234, 256, v234
    v_mul_lo_u32 v235, v234, s44
    v_lshrrev_b32 v235, 16, v235
    v_mul_u32_u24 v236, 20, v235
    v_sub_u32 v236, v234, v236
    v_lshrrev_b32 v237, 6, v235
    v_mul_u32_u24 v237, 320, v237
    v_and_b32 v235, 63, v235
    v_add_u32 v235, v235, v237
    v_mul_lo_u32 v235, v235, s45
    v_lshl_add_u32 v235, v236, 4, v235
    v_add_u32 v242, s30, v235
    buffer_load_dwordx4 v[160:163], v238, s[8:11], 0 offen
    buffer_load_dwordx4 v[164:167], v239, s[8:11], 0 offen
    buffer_load_dwordx4 v[168:171], v240, s[8:11], 0 offen
    buffer_load_dwordx4 v[172:175], v241, s[8:11], 0 offen
    buffer_load_dwordx4 v[176:179], v242, s[8:11], 0 offen
    s_mul_i32 s46, s26, 5120
    v_and_b32 v234, 15, v232
    v_lshrrev_b32 v235, 2, v234
    v_lshl_add_u32 v235, v233, 3, v235
    v_mul_u32_u24 v235, 320, v235
    v_and_b32 v234, 3, v234
    v_lshl_add_u32 v235, v234, 3, v235
    v_bfe_u32 v234, v232, 4, 1
    v_lshl_add_u32 v235, v234, 5, v235
    s_mul_i32 s29, s27, 20480
    s_add_u32 s29, s29, 9216
    v_add_u32 v243, s29, v235
    v_add_u32 v244, 40960, v243
    v_add_u32 v245, 81920, v243
    v_and_b32 v234, 31, v232
    s_lshl_b32 s29, s28, 5
    v_add_u32 v234, s29, v234
    v_lshlrev_b32 v251, 5, v234
    v_mul_u32_u24 v235, 1280, v234
    v_and_b32 v234, 15, v234
    s_mul_i32 s29, s27, 40
    v_add_u32 v236, s29, v233
    s_waitcnt vmcnt(7)
    s_barrier
    v_add_u32 v237, 0, v236
    v_xor_b32 v237, v237, v234
    v_lshl_add_u32 v237, v237, 4, v235
    ds_read_b128 v[0:3], v237
    v_add_u32 v237, 2, v236
    v_xor_b32 v237, v237, v234
    v_lshl_add_u32 v237, v237, 4, v235
    ds_read_b128 v[4:7], v237
    v_add_u32 v237, 4, v236
    v_xor_b32 v237, v237, v234
    v_lshl_add_u32 v237, v237, 4, v235
    ds_read_b128 v[8:11], v237
    v_add_u32 v237, 6, v236
    v_xor_b32 v237, v237, v234
    v_lshl_add_u32 v237, v237, 4, v235
    ds_read_b128 v[12:15], v237
    v_add_u32 v237, 8, v236
    v_xor_b32 v237, v237, v234
    v_lshl_add_u32 v237, v237, 4, v235
    ds_read_b128 v[16:19], v237
    v_add_u32 v237, 10, v236
    v_xor_b32 v237, v237, v234
    v_lshl_add_u32 v237, v237, 4, v235
    ds_read_b128 v[20:23], v237
    v_add_u32 v237, 12, v236
    v_xor_b32 v237, v237, v234
    v_lshl_add_u32 v237, v237, 4, v235
    ds_read_b128 v[24:27], v237
    v_add_u32 v237, 14, v236
    v_xor_b32 v237, v237, v234
    v_lshl_add_u32 v237, v237, 4, v235
    ds_read_b128 v[28:31], v237
    v_add_u32 v237, 16, v236
    v_xor_b32 v237, v237, v234
    v_lshl_add_u32 v237, v237, 4, v235
    ds_read_b128 v[32:35], v237
    v_add_u32 v237, 18, v236
    v_xor_b32 v237, v237, v234
    v_lshl_add_u32 v237, v237, 4, v235
    ds_read_b128 v[36:39], v237
    v_add_u32 v237, 20, v236
    v_xor_b32 v237, v237, v234
    v_lshl_add_u32 v237, v237, 4, v235
    ds_read_b128 v[40:43], v237
    v_add_u32 v237, 22, v236
    v_xor_b32 v237, v237, v234
    v_lshl_add_u32 v237, v237, 4, v235
    ds_read_b128 v[44:47], v237
    v_add_u32 v237, 24, v236
    v_xor_b32 v237, v237, v234
    v_lshl_add_u32 v237, v237, 4, v235
    ds_read_b128 v[48:51], v237
    v_add_u32 v237, 26, v236
    v_xor_b32 v237, v237, v234
    v_lshl_add_u32 v237, v237, 4, v235
    ds_read_b128 v[52:55], v237
    v_add_u32 v237, 28, v236
    v_xor_b32 v237, v237, v234
    v_lshl_add_u32 v237, v237, 4, v235
    ds_read_b128 v[56:59], v237
    v_add_u32 v237, 30, v236
    v_xor_b32 v237, v237, v234
    v_lshl_add_u32 v237, v237, 4, v235
    ds_read_b128 v[60:63], v237
    v_add_u32 v237, 32, v236
    v_xor_b32 v237, v237, v234
    v_lshl_add_u32 v237, v237, 4, v235
    ds_read_b128 v[64:67], v237
    v_add_u32 v237, 34, v236
    v_xor_b32 v237, v237, v234
    v_lshl_add_u32 v237, v237, 4, v235
    ds_read_b128 v[68:71], v237
    v_add_u32 v237, 36, v236
    v_xor_b32 v237, v237, v234
    v_lshl_add_u32 v237, v237, 4, v235
    ds_read_b128 v[72:75], v237
    v_add_u32 v237, 38, v236
    v_xor_b32 v237, v237, v234
    v_lshl_add_u32 v237, v237, 4, v235
    ds_read_b128 v[76:79], v237
    s_waitcnt lgkmcnt(0)
    s_barrier
    s_mov_b32 s47, 81920
    s_add_u32 s48, s46, 50176
    s_mov_b32 m0, s48
    s_nop 0
    buffer_load_dwordx4 v238, s[8:11], s47 offen lds
    s_add_u32 s48, s46, 51200
    s_mov_b32 m0, s48
    s_nop 0
    buffer_load_dwordx4 v239, s[8:11], s47 offen lds
    s_add_u32 s48, s46, 52224
    s_mov_b32 m0, s48
    s_nop 0
    buffer_load_dwordx4 v240, s[8:11], s47 offen lds
    s_add_u32 s48, s46, 53248
    s_mov_b32 m0, s48
    s_nop 0
    buffer_load_dwordx4 v241, s[8:11], s47 offen lds
    s_add_u32 s48, s46, 54272
    s_mov_b32 m0, s48
    s_nop 0
    buffer_load_dwordx4 v242, s[8:11], s47 offen lds
    s_mov_b32 s47, 163840
    s_add_u32 s48, s46, 91136
    s_mov_b32 m0, s48
    s_nop 0
    buffer_load_dwordx4 v238, s[8:11], s47 offen lds
    s_add_u32 s48, s46, 92160
    s_mov_b32 m0, s48
    s_nop 0
    buffer_load_dwordx4 v239, s[8:11], s47 offen lds
    s_add_u32 s48, s46, 93184
    s_mov_b32 m0, s48
    s_nop 0
    buffer_load_dwordx4 v240, s[8:11], s47 offen lds
    s_add_u32 s48, s46, 94208
    s_mov_b32 m0, s48
    s_nop 0
    buffer_load_dwordx4 v241, s[8:11], s47 offen lds
    s_add_u32 s48, s46, 95232
    s_mov_b32 m0, s48
    s_nop 0
    buffer_load_dwordx4 v242, s[8:11], s47 offen lds
    s_waitcnt vmcnt(10)
    v_lshlrev_b32 v234, 4, v232
    v_add_u32 v234, s46, v234
    ds_write_b128 v234, v[160:163] offset:9216
    ds_write_b128 v234, v[164:167] offset:10240
    ds_write_b128 v234, v[168:171] offset:11264
    ds_write_b128 v234, v[172:175] offset:12288
    ds_write_b128 v234, v[176:179] offset:13312
    v_cmp_gt_u32 vcc, 320, v249
    s_and_saveexec_b64 s[50:51], vcc
    s_cbranch_execz L_gb_done
    v_lshlrev_b32 v234, 3, v249
    v_lshlrev_b32 v236, 16, v254
    v_and_b32 v237, 0xffff0000, v254
    ds_write_b64 v234, v[236:237] offset:0
    v_lshlrev_b32 v236, 16, v255
    v_and_b32 v237, 0xffff0000, v255
    ds_write_b64 v234, v[236:237] offset:2560
L_gb_done:
    s_mov_b64 exec, s[50:51]
    v_mov_b32 v252, 0
    v_mov_b32 v253, 0
    s_mov_b32 s49, 0x3f803f80
    v_dot2_f32_bf16 v252, v0, s49, v252
    v_dot2_f32_bf16 v253, v0, v0, v253
    v_dot2_f32_bf16 v252, v1, s49, v252
    v_dot2_f32_bf16 v253, v1, v1, v253
    v_dot2_f32_bf16 v252, v2, s49, v252
    v_dot2_f32_bf16 v253, v2, v2, v253
    v_dot2_f32_bf16 v252, v3, s49, v252
    v_dot2_f32_bf16 v253, v3, v3, v253
    v_dot2_f32_bf16 v252, v4, s49, v252
    v_dot2_f32_bf16 v253, v4, v4, v253
    v_dot2_f32_bf16 v252, v5, s49, v252
    v_dot2_f32_bf16 v253, v5, v5, v253
    v_dot2_f32_bf16 v252, v6, s49, v252
    v_dot2_f32_bf16 v253, v6, v6, v253
    v_dot2_f32_bf16 v252, v7, s49, v252
    v_dot2_f32_bf16 v253, v7, v7, v253
    v_dot2_f32_bf16 v252, v8, s49, v252
    v_dot2_f32_bf16 v253, v8, v8, v253
    v_dot2_f32_bf16 v252, v9, s49, v252
    v_dot2_f32_bf16 v253, v9, v9, v253
    v_dot2_f32_bf16 v252, v10, s49, v252
    v_dot2_f32_bf16 v253, v10, v10, v253
    v_dot2_f32_bf16 v252, v11, s49, v252
    v_dot2_f32_bf16 v253, v11, v11, v253
    v_dot2_f32_bf16 v252, v12, s49, v252
    v_dot2_f32_bf16 v253, v12, v12, v253
    v_dot2_f32_bf16 v252, v13, s49, v252
    v_dot2_f32_bf16 v253, v13, v13, v253
    v_dot2_f32_bf16 v252, v14, s49, v252
    v_dot2_f32_bf16 v253, v14, v14, v253
    v_dot2_f32_bf16 v252, v15, s49, v252
    v_dot2_f32_bf16 v253, v15, v15, v253
    v_dot2_f32_bf16 v252, v16, s49, v252
    v_dot2_f32_bf16 v253, v16, v16, v253
    v_dot2_f32_bf16 v252, v17, s49, v252
    v_dot2_f32_bf16 v253, v17, v17, v253
    v_dot2_f32_bf16 v252, v18, s49, v252
    v_dot2_f32_bf16 v253, v18, v18, v253
    v_dot2_f32_bf16 v252, v19, s49, v252
    v_dot2_f32_bf16 v253, v19, v19, v253
    v_dot2_f32_bf16 v252, v20, s49, v252
    v_dot2_f32_bf16 v253, v20, v20, v253
    v_dot2_f32_bf16 v252, v21, s49, v252
    v_dot2_f32_bf16 v253, v21, v21, v253
    v_dot2_f32_bf16 v252, v22, s49, v252
    v_dot2_f32_bf16 v253, v22, v22, v253
    v_dot2_f32_bf16 v252, v23, s49, v252
    v_dot2_f32_bf16 v253, v23, v23, v253
    v_dot2_f32_bf16 v252, v24, s49, v252
    v_dot2_f32_bf16 v253, v24, v24, v253
    v_dot2_f32_bf16 v252, v25, s49, v252
    v_dot2_f32_bf16 v253, v25, v25, v253
    v_dot2_f32_bf16 v252, v26, s49, v252
    v_dot2_f32_bf16 v253, v26, v26, v253
    v_dot2_f32_bf16 v252, v27, s49, v252
    v_dot2_f32_bf16 v253, v27, v27, v253
    v_dot2_f32_bf16 v252, v28, s49, v252
    v_dot2_f32_bf16 v253, v28, v28, v253
    v_dot2_f32_bf16 v252, v29, s49, v252
    v_dot2_f32_bf16 v253, v29, v29, v253
    v_dot2_f32_bf16 v252, v30, s49, v252
    v_dot2_f32_bf16 v253, v30, v30, v253
    v_dot2_f32_bf16 v252, v31, s49, v252
    v_dot2_f32_bf16 v253, v31, v31, v253
    v_dot2_f32_bf16 v252, v32, s49, v252
    v_dot2_f32_bf16 v253, v32, v32, v253
    v_dot2_f32_bf16 v252, v33, s49, v252
    v_dot2_f32_bf16 v253, v33, v33, v253
    v_dot2_f32_bf16 v252, v34, s49, v252
    v_dot2_f32_bf16 v253, v34, v34, v253
    v_dot2_f32_bf16 v252, v35, s49, v252
    v_dot2_f32_bf16 v253, v35, v35, v253
    v_dot2_f32_bf16 v252, v36, s49, v252
    v_dot2_f32_bf16 v253, v36, v36, v253
    v_dot2_f32_bf16 v252, v37, s49, v252
    v_dot2_f32_bf16 v253, v37, v37, v253
    v_dot2_f32_bf16 v252, v38, s49, v252
    v_dot2_f32_bf16 v253, v38, v38, v253
    v_dot2_f32_bf16 v252, v39, s49, v252
    v_dot2_f32_bf16 v253, v39, v39, v253
    v_dot2_f32_bf16 v252, v40, s49, v252
    v_dot2_f32_bf16 v253, v40, v40, v253
    v_dot2_f32_bf16 v252, v41, s49, v252
    v_dot2_f32_bf16 v253, v41, v41, v253
    v_dot2_f32_bf16 v252, v42, s49, v252
    v_dot2_f32_bf16 v253, v42, v42, v253
    v_dot2_f32_bf16 v252, v43, s49, v252
    v_dot2_f32_bf16 v253, v43, v43, v253
    v_dot2_f32_bf16 v252, v44, s49, v252
    v_dot2_f32_bf16 v253, v44, v44, v253
    v_dot2_f32_bf16 v252, v45, s49, v252
    v_dot2_f32_bf16 v253, v45, v45, v253
    v_dot2_f32_bf16 v252, v46, s49, v252
    v_dot2_f32_bf16 v253, v46, v46, v253
    v_dot2_f32_bf16 v252, v47, s49, v252
    v_dot2_f32_bf16 v253, v47, v47, v253
    v_dot2_f32_bf16 v252, v48, s49, v252
    v_dot2_f32_bf16 v253, v48, v48, v253
    v_dot2_f32_bf16 v252, v49, s49, v252
    v_dot2_f32_bf16 v253, v49, v49, v253
    v_dot2_f32_bf16 v252, v50, s49, v252
    v_dot2_f32_bf16 v253, v50, v50, v253
    v_dot2_f32_bf16 v252, v51, s49, v252
    v_dot2_f32_bf16 v253, v51, v51, v253
    v_dot2_f32_bf16 v252, v52, s49, v252
    v_dot2_f32_bf16 v253, v52, v52, v253
    v_dot2_f32_bf16 v252, v53, s49, v252
    v_dot2_f32_bf16 v253, v53, v53, v253
    v_dot2_f32_bf16 v252, v54, s49, v252
    v_dot2_f32_bf16 v253, v54, v54, v253
    v_dot2_f32_bf16 v252, v55, s49, v252
    v_dot2_f32_bf16 v253, v55, v55, v253
    v_dot2_f32_bf16 v252, v56, s49, v252
    v_dot2_f32_bf16 v253, v56, v56, v253
    v_dot2_f32_bf16 v252, v57, s49, v252
    v_dot2_f32_bf16 v253, v57, v57, v253
    v_dot2_f32_bf16 v252, v58, s49, v252
    v_dot2_f32_bf16 v253, v58, v58, v253
    v_dot2_f32_bf16 v252, v59, s49, v252
    v_dot2_f32_bf16 v253, v59, v59, v253
    v_dot2_f32_bf16 v252, v60, s49, v252
    v_dot2_f32_bf16 v253, v60, v60, v253
    v_dot2_f32_bf16 v252, v61, s49, v252
    v_dot2_f32_bf16 v253, v61, v61, v253
    v_dot2_f32_bf16 v252, v62, s49, v252
    v_dot2_f32_bf16 v253, v62, v62, v253
    v_dot2_f32_bf16 v252, v63, s49, v252
    v_dot2_f32_bf16 v253, v63, v63, v253
    v_dot2_f32_bf16 v252, v64, s49, v252
    v_dot2_f32_bf16 v253, v64, v64, v253
    v_dot2_f32_bf16 v252, v65, s49, v252
    v_dot2_f32_bf16 v253, v65, v65, v253
    v_dot2_f32_bf16 v252, v66, s49, v252
    v_dot2_f32_bf16 v253, v66, v66, v253
    v_dot2_f32_bf16 v252, v67, s49, v252
    v_dot2_f32_bf16 v253, v67, v67, v253
    v_dot2_f32_bf16 v252, v68, s49, v252
    v_dot2_f32_bf16 v253, v68, v68, v253
    v_dot2_f32_bf16 v252, v69, s49, v252
    v_dot2_f32_bf16 v253, v69, v69, v253
    v_dot2_f32_bf16 v252, v70, s49, v252
    v_dot2_f32_bf16 v253, v70, v70, v253
    v_dot2_f32_bf16 v252, v71, s49, v252
    v_dot2_f32_bf16 v253, v71, v71, v253
    v_dot2_f32_bf16 v252, v72, s49, v252
    v_dot2_f32_bf16 v253, v72, v72, v253
    v_dot2_f32_bf16 v252, v73, s49, v252
    v_dot2_f32_bf16 v253, v73, v73, v253
    v_dot2_f32_bf16 v252, v74, s49, v252
    v_dot2_f32_bf16 v253, v74, v74, v253
    v_dot2_f32_bf16 v252, v75, s49, v252
    v_dot2_f32_bf16 v253, v75, v75, v253
    v_dot2_f32_bf16 v252, v76, s49, v252
    v_dot2_f32_bf16 v253, v76, v76, v253
    v_dot2_f32_bf16 v252, v77, s49, v252
    v_dot2_f32_bf16 v253, v77, v77, v253
    v_dot2_f32_bf16 v252, v78, s49, v252
    v_dot2_f32_bf16 v253, v78, v78, v253
    v_dot2_f32_bf16 v252, v79, s49, v252
    v_dot2_f32_bf16 v253, v79, v79, v253
    s_lshl_b32 s29, s27, 4
    v_lshl_add_u32 v234, v233, 3, s29
    v_add_u32 v234, v234, v251
    ds_write_b64 v234, v[252:253] offset:5120
    s_waitcnt lgkmcnt(0)
    s_barrier
    s_mul_i32 s29, s27, 1280
    v_lshl_add_u32 v248, v233, 5, s29
    ds_read_b128 v[180:183], v251 offset:5120
    ds_read_b128 v[184:187], v251 offset:5136
    ds_read_b128 v[200:203], v248 offset:0
    ds_read_b128 v[204:207], v248 offset:16
    ds_read_b128 v[208:211], v248 offset:2560
    ds_read_b128 v[212:215], v248 offset:2576
    ds_read_b64_tr_b16 v[160:161], v243 offset:0
    ds_read_b64_tr_b16 v[162:163], v243 offset:1280
    ds_read_b64_tr_b16 v[164:165], v243 offset:64
    ds_read_b64_tr_b16 v[166:167], v243 offset:1344
    ds_read_b64_tr_b16 v[168:169], v243 offset:128
    ds_read_b64_tr_b16 v[170:171], v243 offset:1408
    ds_read_b64_tr_b16 v[172:173], v243 offset:192
    ds_read_b64_tr_b16 v[174:175], v243 offset:1472
    ds_read_b64_tr_b16 v[176:177], v243 offset:256
    ds_read_b64_tr_b16 v[178:179], v243 offset:1536
    s_waitcnt lgkmcnt(14)
    v_add_f32 v252, v180, v182
    v_add_f32 v234, v184, v186
    v_add_f32 v252, v252, v234
    v_add_f32 v253, v181, v183
    v_add_f32 v234, v185, v187
    v_add_f32 v253, v253, v234
    v_mul_f32 v252, 0x3acccccd, v252
    v_mul_f32 v253, 0x3acccccd, v253
    v_fma_f32 v253, -v252, v252, v253
    v_max_f32 v253, 0, v253
    v_add_f32 v253, 0x3727c5ac, v253
    v_rsq_f32 v246, v253
    s_nop 0
    v_mul_f32 v247, v252, v246
    v_sub_f32 v247, 0, v247
    s_waitcnt lgkmcnt(10)
    v_lshlrev_b32 v234, 16, v0
    v_and_b32 v235, 0xffff0000, v0
    v_fma_f32 v234, v234, v246, v247
    v_fma_f32 v235, v235, v246, v247
    v_fma_f32 v234, v234, v200, v208
    v_fma_f32 v235, v235, v201, v209
    v_cvt_pk_bf16_f32 v0, v234, v235
    v_lshlrev_b32 v234, 16, v1
    v_and_b32 v235, 0xffff0000, v1
    v_fma_f32 v234, v234, v246, v247
    v_fma_f32 v235, v235, v246, v247
    v_fma_f32 v234, v234, v202, v210
    v_fma_f32 v235, v235, v203, v211
    v_cvt_pk_bf16_f32 v1, v234, v235
    v_lshlrev_b32 v234, 16, v2
    v_and_b32 v235, 0xffff0000, v2
    v_fma_f32 v234, v234, v246, v247
    v_fma_f32 v235, v235, v246, v247
    v_fma_f32 v234, v234, v204, v212
    v_fma_f32 v235, v235, v205, v213
    v_cvt_pk_bf16_f32 v2, v234, v235
    v_lshlrev_b32 v234, 16, v3
    v_and_b32 v235, 0xffff0000, v3
    v_fma_f32 v234, v234, v246, v247
    v_fma_f32 v235, v235, v246, v247
    v_fma_f32 v234, v234, v206, v214
    v_fma_f32 v235, v235, v207, v215
    v_cvt_pk_bf16_f32 v3, v234, v235
    ds_read_b128 v[216:219], v248 offset:64
    ds_read_b128 v[220:223], v248 offset:80
    ds_read_b128 v[224:227], v248 offset:2624
    ds_read_b128 v[228:231], v248 offset:2640
    ds_read_b64_tr_b16 v[180:181], v243 offset:5120
    ds_read_b64_tr_b16 v[182:183], v243 offset:6400
    ds_read_b64_tr_b16 v[184:185], v243 offset:5184
    ds_read_b64_tr_b16 v[186:187], v243 offset:6464
    ds_read_b64_tr_b16 v[188:189], v243 offset:5248
    ds_read_b64_tr_b16 v[190:191], v243 offset:6528
    ds_read_b64_tr_b16 v[192:193], v243 offset:5312
    ds_read_b64_tr_b16 v[194:195], v243 offset:6592
    ds_read_b64_tr_b16 v[196:197], v243 offset:5376
    ds_read_b64_tr_b16 v[198:199], v243 offset:6656
    ds_read_b128 v[200:203], v248 offset:128
    ds_read_b128 v[204:207], v248 offset:144
    ds_read_b128 v[208:211], v248 offset:2688
    ds_read_b128 v[212:215], v248 offset:2704
    s_waitcnt lgkmcnt(15)
    v_mfma_f32_32x32x16_bf16 v[80:95], v[160:163], v[0:3], 0
    v_mfma_f32_32x32x16_bf16 v[96:111], v[164:167], v[0:3], 0
    v_mfma_f32_32x32x16_bf16 v[112:127], v[168:171], v[0:3], 0
    v_mfma_f32_32x32x16_bf16 v[128:143], v[172:175], v[0:3], 0
    v_mfma_f32_32x32x16_bf16 v[144:159], v[176:179], v[0:3], 0
    s_waitcnt lgkmcnt(14)
    v_lshlrev_b32 v234, 16, v4
    v_and_b32 v235, 0xffff0000, v4
    v_fma_f32 v234, v234, v246, v247
    v_fma_f32 v235, v235, v246, v247
    v_fma_f32 v234, v234, v216, v224
    v_fma_f32 v235, v235, v217, v225
    v_cvt_pk_bf16_f32 v4, v234, v235
    v_lshlrev_b32 v234, 16, v5
    v_and_b32 v235, 0xffff0000, v5
    v_fma_f32 v234, v234, v246, v247
    v_fma_f32 v235, v235, v246, v247
    v_fma_f32 v234, v234, v218, v226
    v_fma_f32 v235, v235, v219, v227
    v_cvt_pk_bf16_f32 v5, v234, v235
    v_lshlrev_b32 v234, 16, v6
    v_and_b32 v235, 0xffff0000, v6
    v_fma_f32 v234, v234, v246, v247
    v_fma_f32 v235, v235, v246, v247
    v_fma_f32 v234, v234, v220, v228
    v_fma_f32 v235, v235, v221, v229
    v_cvt_pk_bf16_f32 v6, v234, v235
    v_lshlrev_b32 v234, 16, v7
    v_and_b32 v235, 0xffff0000, v7
    v_fma_f32 v234, v234, v246, v247
    v_fma_f32 v235, v235, v246, v247
    v_fma_f32 v234, v234, v222, v230
    v_fma_f32 v235, v235, v223, v231
    v_cvt_pk_bf16_f32 v7, v234, v235
    s_nop 1
    ds_read_b64_tr_b16 v[160:161], v243 offset:10240
    ds_read_b64_tr_b16 v[162:163], v243 offset:11520
    ds_read_b64_tr_b16 v[164:165], v243 offset:10304
    ds_read_b64_tr_b16 v[166:167], v243 offset:11584
    ds_read_b64_tr_b16 v[168:169], v243 offset:10368
    ds_read_b64_tr_b16 v[170:171], v243 offset:11648
    ds_read_b64_tr_b16 v[172:173], v243 offset:10432
    ds_read_b64_tr_b16 v[174:175], v243 offset:11712
    ds_read_b64_tr_b16 v[176:177], v243 offset:10496
    ds_read_b64_tr_b16 v[178:179], v243 offset:11776
    ds_read_b128 v[216:219], v248 offset:192
    ds_read_b128 v[220:223], v248 offset:208
    ds_read_b128 v[224:227], v248 offset:2752
    ds_read_b128 v[228:231], v248 offset:2768
    s_waitcnt lgkmcnt(15)
    v_mfma_f32_32x32x16_bf16 v[80:95], v[180:183], v[4:7], v[80:95]
    v_mfma_f32_32x32x16_bf16 v[96:111], v[184:187], v[4:7], v[96:111]
    v_mfma_f32_32x32x16_bf16 v[112:127], v[188:191], v[4:7], v[112:127]
    v_mfma_f32_32x32x16_bf16 v[128:143], v[192:195], v[4:7], v[128:143]
    v_mfma_f32_32x32x16_bf16 v[144:159], v[196:199], v[4:7], v[144:159]
    s_waitcnt lgkmcnt(14)
    v_lshlrev_b32 v234, 16, v8
    v_and_b32 v235, 0xffff0000, v8
    v_fma_f32 v234, v234, v246, v247
    v_fma_f32 v235, v235, v246, v247
    v_fma_f32 v234, v234, v200, v208
    v_fma_f32 v235, v235, v201, v209
    v_cvt_pk_bf16_f32 v8, v234, v235
    v_lshlrev_b32 v234, 16, v9
    v_and_b32 v235, 0xffff0000, v9
    v_fma_f32 v234, v234, v246, v247
    v_fma_f32 v235, v235, v246, v247
    v_fma_f32 v234, v234, v202, v210
    v_fma_f32 v235, v235, v203, v211
    v_cvt_pk_bf16_f32 v9, v234, v235
    v_lshlrev_b32 v234, 16, v10
    v_and_b32 v235, 0xffff0000, v10
    v_fma_f32 v234, v234, v246, v247
    v_fma_f32 v235, v235, v246, v247
    v_fma_f32 v234, v234, v204, v212
    v_fma_f32 v235, v235, v205, v213
    v_cvt_pk_bf16_f32 v10, v234, v235
    v_lshlrev_b32 v234, 16, v11
    v_and_b32 v235, 0xffff0000, v11
    v_fma_f32 v234, v234, v246, v247
    v_fma_f32 v235, v235, v246, v247
    v_fma_f32 v234, v234, v206, v214
    v_fma_f32 v235, v235, v207, v215
    v_cvt_pk_bf16_f32 v11, v234, v235
    s_nop 1
    ds_read_b64_tr_b16 v[180:181], v243 offset:15360
    ds_read_b64_tr_b16 v[182:183], v243 offset:16640
    ds_read_b64_tr_b16 v[184:185], v243 offset:15424
    ds_read_b64_tr_b16 v[186:187], v243 offset:16704
    ds_read_b64_tr_b16 v[188:189], v243 offset:15488
    ds_read_b64_tr_b16 v[190:191], v243 offset:16768
    ds_read_b64_tr_b16 v[192:193], v243 offset:15552
    ds_read_b64_tr_b16 v[194:195], v243 offset:16832
    ds_read_b64_tr_b16 v[196:197], v243 offset:15616
    ds_read_b64_tr_b16 v[198:199], v243 offset:16896
    ds_read_b128 v[200:203], v248 offset:256
    ds_read_b128 v[204:207], v248 offset:272
    ds_read_b128 v[208:211], v248 offset:2816
    ds_read_b128 v[212:215], v248 offset:2832
    s_waitcnt lgkmcnt(15)
    v_mfma_f32_32x32x16_bf16 v[80:95], v[160:163], v[8:11], v[80:95]
    v_mfma_f32_32x32x16_bf16 v[96:111], v[164:167], v[8:11], v[96:111]
    v_mfma_f32_32x32x16_bf16 v[112:127], v[168:171], v[8:11], v[112:127]
    v_mfma_f32_32x32x16_bf16 v[128:143], v[172:175], v[8:11], v[128:143]
    v_mfma_f32_32x32x16_bf16 v[144:159], v[176:179], v[8:11], v[144:159]
    s_waitcnt lgkmcnt(14)
    v_lshlrev_b32 v234, 16, v12
    v_and_b32 v235, 0xffff0000, v12
    v_fma_f32 v234, v234, v246, v247
    v_fma_f32 v235, v235, v246, v247
    v_fma_f32 v234, v234, v216, v224
    v_fma_f32 v235, v235, v217, v225
    v_cvt_pk_bf16_f32 v12, v234, v235
    v_lshlrev_b32 v234, 16, v13
    v_and_b32 v235, 0xffff0000, v13
    v_fma_f32 v234, v234, v246, v247
    v_fma_f32 v235, v235, v246, v247
    v_fma_f32 v234, v234, v218, v226
    v_fma_f32 v235, v235, v219, v227
    v_cvt_pk_bf16_f32 v13, v234, v235
    v_lshlrev_b32 v234, 16, v14
    v_and_b32 v235, 0xffff0000, v14
    v_fma_f32 v234, v234, v246, v247
    v_fma_f32 v235, v235, v246, v247
    v_fma_f32 v234, v234, v220, v228
    v_fma_f32 v235, v235, v221, v229
    v_cvt_pk_bf16_f32 v14, v234, v235
    v_lshlrev_b32 v234, 16, v15
    v_and_b32 v235, 0xffff0000, v15
    v_fma_f32 v234, v234, v246, v247
    v_fma_f32 v235, v235, v246, v247
    v_fma_f32 v234, v234, v222, v230
    v_fma_f32 v235, v235, v223, v231
    v_cvt_pk_bf16_f32 v15, v234, v235
    s_nop 1
    ds_read_b128 v[216:219], v248 offset:320
    ds_read_b128 v[220:223], v248 offset:336
    ds_read_b128 v[224:227], v248 offset:2880
    ds_read_b128 v[228:231], v248 offset:2896
    s_waitcnt lgkmcnt(8)
    v_mfma_f32_32x32x16_bf16 v[80:95], v[180:183], v[12:15], v[80:95]
    v_mfma_f32_32x32x16_bf16 v[96:111], v[184:187], v[12:15], v[96:111]
    v_mfma_f32_32x32x16_bf16 v[112:127], v[188:191], v[12:15], v[112:127]
    v_mfma_f32_32x32x16_bf16 v[128:143], v[192:195], v[12:15], v[128:143]
    v_mfma_f32_32x32x16_bf16 v[144:159], v[196:199], v[12:15], v[144:159]
    s_waitcnt lgkmcnt(4)
    v_lshlrev_b32 v234, 16, v16
    v_and_b32 v235, 0xffff0000, v16
    v_fma_f32 v234, v234, v246, v247
    v_fma_f32 v235, v235, v246, v247
    v_fma_f32 v234, v234, v200, v208
    v_fma_f32 v235, v235, v201, v209
    v_cvt_pk_bf16_f32 v16, v234, v235
    v_lshlrev_b32 v234, 16, v17
    v_and_b32 v235, 0xffff0000, v17
    v_fma_f32 v234, v234, v246, v247
    v_fma_f32 v235, v235, v246, v247
    v_fma_f32 v234, v234, v202, v210
    v_fma_f32 v235, v235, v203, v211
    v_cvt_pk_bf16_f32 v17, v234, v235
    v_lshlrev_b32 v234, 16, v18
    v_and_b32 v235, 0xffff0000, v18
    v_fma_f32 v234, v234, v246, v247
    v_fma_f32 v235, v235, v246, v247
    v_fma_f32 v234, v234, v204, v212
    v_fma_f32 v235, v235, v205, v213
    v_cvt_pk_bf16_f32 v18, v234, v235
    v_lshlrev_b32 v234, 16, v19
    v_and_b32 v235, 0xffff0000, v19
    v_fma_f32 v234, v234, v246, v247
    v_fma_f32 v235, v235, v246, v247
    v_fma_f32 v234, v234, v206, v214
    v_fma_f32 v235, v235, v207, v215
    v_cvt_pk_bf16_f32 v19, v234, v235
    s_nop 1
    s_waitcnt vmcnt(5)
    s_barrier
    ds_read_b64_tr_b16 v[160:161], v244 offset:0
    ds_read_b64_tr_b16 v[162:163], v244 offset:1280
    ds_read_b64_tr_b16 v[164:165], v244 offset:64
    ds_read_b64_tr_b16 v[166:167], v244 offset:1344
    ds_read_b64_tr_b16 v[168:169], v244 offset:128
    ds_read_b64_tr_b16 v[170:171], v244 offset:1408
    ds_read_b64_tr_b16 v[172:173], v244 offset:192
    ds_read_b64_tr_b16 v[174:175], v244 offset:1472
    ds_read_b64_tr_b16 v[176:177], v244 offset:256
    ds_read_b64_tr_b16 v[178:179], v244 offset:1536
    s_mov_b32 s47, 245760
    s_add_u32 s48, s46, 9216
    s_mov_b32 m0, s48
    s_nop 0
    buffer_load_dwordx4 v238, s[8:11], s47 offen lds
    s_add_u32 s48, s46, 10240
    s_mov_b32 m0, s48
    s_nop 0
    buffer_load_dwordx4 v239, s[8:11], s47 offen lds
    s_add_u32 s48, s46, 11264
    s_mov_b32 m0, s48
    s_nop 0
    buffer_load_dwordx4 v240, s[8:11], s47 offen lds
    s_add_u32 s48, s46, 12288
    s_mov_b32 m0, s48
    s_nop 0
    buffer_load_dwordx4 v241, s[8:11], s47 offen lds
    s_add_u32 s48, s46, 13312
    s_mov_b32 m0, s48
    s_nop 0
    buffer_load_dwordx4 v242, s[8:11], s47 offen lds
    ds_read_b64_tr_b16 v[180:181], v244 offset:5120
    ds_read_b64_tr_b16 v[182:183], v244 offset:6400
    ds_read_b64_tr_b16 v[184:185], v244 offset:5184
    ds_read_b64_tr_b16 v[186:187], v244 offset:6464
    ds_read_b64_tr_b16 v[188:189], v244 offset:5248
    ds_read_b64_tr_b16 v[190:191], v244 offset:6528
    ds_read_b64_tr_b16 v[192:193], v244 offset:5312
    ds_read_b64_tr_b16 v[194:195], v244 offset:6592
    ds_read_b64_tr_b16 v[196:197], v244 offset:5376
    ds_read_b64_tr_b16 v[198:199], v244 offset:6656
    ds_read_b128 v[200:203], v248 offset:384
    ds_read_b128 v[204:207], v248 offset:400
    ds_read_b128 v[208:211], v248 offset:2944
    ds_read_b128 v[212:215], v248 offset:2960
    s_waitcnt lgkmcnt(14)
    v_mfma_f32_32x32x16_bf16 v[80:95], v[160:163], v[16:19], v[80:95]
    v_mfma_f32_32x32x16_bf16 v[96:111], v[164:167], v[16:19], v[96:111]
    v_mfma_f32_32x32x16_bf16 v[112:127], v[168:171], v[16:19], v[112:127]
    v_mfma_f32_32x32x16_bf16 v[128:143], v[172:175], v[16:19], v[128:143]
    v_mfma_f32_32x32x16_bf16 v[144:159], v[176:179], v[16:19], v[144:159]
    s_waitcnt lgkmcnt(14)
    v_lshlrev_b32 v234, 16, v20
    v_and_b32 v235, 0xffff0000, v20
    v_fma_f32 v234, v234, v246, v247
    v_fma_f32 v235, v235, v246, v247
    v_fma_f32 v234, v234, v216, v224
    v_fma_f32 v235, v235, v217, v225
    v_cvt_pk_bf16_f32 v20, v234, v235
    v_lshlrev_b32 v234, 16, v21
    v_and_b32 v235, 0xffff0000, v21
    v_fma_f32 v234, v234, v246, v247
    v_fma_f32 v235, v235, v246, v247
    v_fma_f32 v234, v234, v218, v226
    v_fma_f32 v235, v235, v219, v227
    v_cvt_pk_bf16_f32 v21, v234, v235
    v_lshlrev_b32 v234, 16, v22
    v_and_b32 v235, 0xffff0000, v22
    v_fma_f32 v234, v234, v246, v247
    v_fma_f32 v235, v235, v246, v247
    v_fma_f32 v234, v234, v220, v228
    v_fma_f32 v235, v235, v221, v229
    v_cvt_pk_bf16_f32 v22, v234, v235
    v_lshlrev_b32 v234, 16, v23
    v_and_b32 v235, 0xffff0000, v23
    v_fma_f32 v234, v234, v246, v247
    v_fma_f32 v235, v235, v246, v247
    v_fma_f32 v234, v234, v222, v230
    v_fma_f32 v235, v235, v223, v231
    v_cvt_pk_bf16_f32 v23, v234, v235
    s_nop 1
    ds_read_b64_tr_b16 v[160:161], v244 offset:10240
    ds_read_b64_tr_b16 v[162:163], v244 offset:11520
    ds_read_b64_tr_b16 v[164:165], v244 offset:10304
    ds_read_b64_tr_b16 v[166:167], v244 offset:11584
    ds_read_b64_tr_b16 v[168:169], v244 offset:10368
    ds_read_b64_tr_b16 v[170:171], v244 offset:11648
    ds_read_b64_tr_b16 v[172:173], v244 offset:10432
    ds_read_b64_tr_b16 v[174:175], v244 offset:11712
    ds_read_b64_tr_b16 v[176:177], v244 offset:10496
    ds_read_b64_tr_b16 v[178:179], v244 offset:11776
    ds_read_b128 v[216:219], v248 offset:448
    ds_read_b128 v[220:223], v248 offset:464
    ds_read_b128 v[224:227], v248 offset:3008
    ds_read_b128 v[228:231], v248 offset:3024
    s_waitcnt lgkmcnt(15)
    v_mfma_f32_32x32x16_bf16 v[80:95], v[180:183], v[20:23], v[80:95]
    v_mfma_f32_32x32x16_bf16 v[96:111], v[184:187], v[20:23], v[96:111]
    v_mfma_f32_32x32x16_bf16 v[112:127], v[188:191], v[20:23], v[112:127]
    v_mfma_f32_32x32x16_bf16 v[128:143], v[192:195], v[20:23], v[128:143]
    v_mfma_f32_32x32x16_bf16 v[144:159], v[196:199], v[20:23], v[144:159]
    s_waitcnt lgkmcnt(14)
    v_lshlrev_b32 v234, 16, v24
    v_and_b32 v235, 0xffff0000, v24
    v_fma_f32 v234, v234, v246, v247
    v_fma_f32 v235, v235, v246, v247
    v_fma_f32 v234, v234, v200, v208
    v_fma_f32 v235, v235, v201, v209
    v_cvt_pk_bf16_f32 v24, v234, v235
    v_lshlrev_b32 v234, 16, v25
    v_and_b32 v235, 0xffff0000, v25
    v_fma_f32 v234, v234, v246, v247
    v_fma_f32 v235, v235, v246, v247
    v_fma_f32 v234, v234, v202, v210
    v_fma_f32 v235, v235, v203, v211
    v_cvt_pk_bf16_f32 v25, v234, v235
    v_lshlrev_b32 v234, 16, v26
    v_and_b32 v235, 0xffff0000, v26
    v_fma_f32 v234, v234, v246, v247
    v_fma_f32 v235, v235, v246, v247
    v_fma_f32 v234, v234, v204, v212
    v_fma_f32 v235, v235, v205, v213
    v_cvt_pk_bf16_f32 v26, v234, v235
    v_lshlrev_b32 v234, 16, v27
    v_and_b32 v235, 0xffff0000, v27
    v_fma_f32 v234, v234, v246, v247
    v_fma_f32 v235, v235, v246, v247
    v_fma_f32 v234, v234, v206, v214
    v_fma_f32 v235, v235, v207, v215
    v_cvt_pk_bf16_f32 v27, v234, v235
    s_nop 1
    ds_read_b64_tr_b16 v[180:181], v244 offset:15360
    ds_read_b64_tr_b16 v[182:183], v244 offset:16640
    ds_read_b64_tr_b16 v[184:185], v244 offset:15424
    ds_read_b64_tr_b16 v[186:187], v244 offset:16704
    ds_read_b64_tr_b16 v[188:189], v244 offset:15488
    ds_read_b64_tr_b16 v[190:191], v244 offset:16768
    ds_read_b64_tr_b16 v[192:193], v244 offset:15552
    ds_read_b64_tr_b16 v[194:195], v244 offset:16832
    ds_read_b64_tr_b16 v[196:197], v244 offset:15616
    ds_read_b64_tr_b16 v[198:199], v244 offset:16896
    ds_read_b128 v[200:203], v248 offset:512
    ds_read_b128 v[204:207], v248 offset:528
    ds_read_b128 v[208:211], v248 offset:3072
    ds_read_b128 v[212:215], v248 offset:3088
    s_waitcnt lgkmcnt(15)
    v_mfma_f32_32x32x16_bf16 v[80:95], v[160:163], v[24:27], v[80:95]
    v_mfma_f32_32x32x16_bf16 v[96:111], v[164:167], v[24:27], v[96:111]
    v_mfma_f32_32x32x16_bf16 v[112:127], v[168:171], v[24:27], v[112:127]
    v_mfma_f32_32x32x16_bf16 v[128:143], v[172:175], v[24:27], v[128:143]
    v_mfma_f32_32x32x16_bf16 v[144:159], v[176:179], v[24:27], v[144:159]
    s_waitcnt lgkmcnt(14)
    v_lshlrev_b32 v234, 16, v28
    v_and_b32 v235, 0xffff0000, v28
    v_fma_f32 v234, v234, v246, v247
    v_fma_f32 v235, v235, v246, v247
    v_fma_f32 v234, v234, v216, v224
    v_fma_f32 v235, v235, v217, v225
    v_cvt_pk_bf16_f32 v28, v234, v235
    v_lshlrev_b32 v234, 16, v29
    v_and_b32 v235, 0xffff0000, v29
    v_fma_f32 v234, v234, v246, v247
    v_fma_f32 v235, v235, v246, v247
    v_fma_f32 v234, v234, v218, v226
    v_fma_f32 v235, v235, v219, v227
    v_cvt_pk_bf16_f32 v29, v234, v235
    v_lshlrev_b32 v234, 16, v30
    v_and_b32 v235, 0xffff0000, v30
    v_fma_f32 v234, v234, v246, v247
    v_fma_f32 v235, v235, v246, v247
    v_fma_f32 v234, v234, v220, v228
    v_fma_f32 v235, v235, v221, v229
    v_cvt_pk_bf16_f32 v30, v234, v235
    v_lshlrev_b32 v234, 16, v31
    v_and_b32 v235, 0xffff0000, v31
    v_fma_f32 v234, v234, v246, v247
    v_fma_f32 v235, v235, v246, v247
    v_fma_f32 v234, v234, v222, v230
    v_fma_f32 v235, v235, v223, v231
    v_cvt_pk_bf16_f32 v31, v234, v235
    s_nop 1
    ds_read_b128 v[216:219], v248 offset:576
    ds_read_b128 v[220:223], v248 offset:592
    ds_read_b128 v[224:227], v248 offset:3136
    ds_read_b128 v[228:231], v248 offset:3152
    s_waitcnt lgkmcnt(8)
    v_mfma_f32_32x32x16_bf16 v[80:95], v[180:183], v[28:31], v[80:95]
    v_mfma_f32_32x32x16_bf16 v[96:111], v[184:187], v[28:31], v[96:111]
    v_mfma_f32_32x32x16_bf16 v[112:127], v[188:191], v[28:31], v[112:127]
    v_mfma_f32_32x32x16_bf16 v[128:143], v[192:195], v[28:31], v[128:143]
    v_mfma_f32_32x32x16_bf16 v[144:159], v[196:199], v[28:31], v[144:159]
    s_waitcnt lgkmcnt(4)
    v_lshlrev_b32 v234, 16, v32
    v_and_b32 v235, 0xffff0000, v32
    v_fma_f32 v234, v234, v246, v247
    v_fma_f32 v235, v235, v246, v247
    v_fma_f32 v234, v234, v200, v208
    v_fma_f32 v235, v235, v201, v209
    v_cvt_pk_bf16_f32 v32, v234, v235
    v_lshlrev_b32 v234, 16, v33
    v_and_b32 v235, 0xffff0000, v33
    v_fma_f32 v234, v234, v246, v247
    v_fma_f32 v235, v235, v246, v247
    v_fma_f32 v234, v234, v202, v210
    v_fma_f32 v235, v235, v203, v211
    v_cvt_pk_bf16_f32 v33, v234, v235
    v_lshlrev_b32 v234, 16, v34
    v_and_b32 v235, 0xffff0000, v34
    v_fma_f32 v234, v234, v246, v247
    v_fma_f32 v235, v235, v246, v247
    v_fma_f32 v234, v234, v204, v212
    v_fma_f32 v235, v235, v205, v213
    v_cvt_pk_bf16_f32 v34, v234, v235
    v_lshlrev_b32 v234, 16, v35
    v_and_b32 v235, 0xffff0000, v35
    v_fma_f32 v234, v234, v246, v247
    v_fma_f32 v235, v235, v246, v247
    v_fma_f32 v234, v234, v206, v214
    v_fma_f32 v235, v235, v207, v215
    v_cvt_pk_bf16_f32 v35, v234, v235
    s_nop 1
    s_waitcnt vmcnt(5)
    s_barrier
    ds_read_b64_tr_b16 v[160:161], v245 offset:0
    ds_read_b64_tr_b16 v[162:163], v245 offset:1280
    ds_read_b64_tr_b16 v[164:165], v245 offset:64
    ds_read_b64_tr_b16 v[166:167], v245 offset:1344
    ds_read_b64_tr_b16 v[168:169], v245 offset:128
    ds_read_b64_tr_b16 v[170:171], v245 offset:1408
    ds_read_b64_tr_b16 v[172:173], v245 offset:192
    ds_read_b64_tr_b16 v[174:175], v245 offset:1472
    ds_read_b64_tr_b16 v[176:177], v245 offset:256
    ds_read_b64_tr_b16 v[178:179], v245 offset:1536
    s_mov_b32 s47, 327680
    s_add_u32 s48, s46, 50176
    s_mov_b32 m0, s48
    s_nop 0
    buffer_load_dwordx4 v238, s[8:11], s47 offen lds
    s_add_u32 s48, s46, 51200
    s_mov_b32 m0, s48
    s_nop 0
    buffer_load_dwordx4 v239, s[8:11], s47 offen lds
    s_add_u32 s48, s46, 52224
    s_mov_b32 m0, s48
    s_nop 0
    buffer_load_dwordx4 v240, s[8:11], s47 offen lds
    s_add_u32 s48, s46, 53248
    s_mov_b32 m0, s48
    s_nop 0
    buffer_load_dwordx4 v241, s[8:11], s47 offen lds
    s_add_u32 s48, s46, 54272
    s_mov_b32 m0, s48
    s_nop 0
    buffer_load_dwordx4 v242, s[8:11], s47 offen lds
    ds_read_b64_tr_b16 v[180:181], v245 offset:5120
    ds_read_b64_tr_b16 v[182:183], v245 offset:6400
    ds_read_b64_tr_b16 v[184:185], v245 offset:5184
    ds_read_b64_tr_b16 v[186:187], v245 offset:6464
    ds_read_b64_tr_b16 v[188:189], v245 offset:5248
    ds_read_b64_tr_b16 v[190:191], v245 offset:6528
    ds_read_b64_tr_b16 v[192:193], v245 offset:5312
    ds_read_b64_tr_b16 v[194:195], v245 offset:6592
    ds_read_b64_tr_b16 v[196:197], v245 offset:5376
    ds_read_b64_tr_b16 v[198:199], v245 offset:6656
    ds_read_b128 v[200:203], v248 offset:640
    ds_read_b128 v[204:207], v248 offset:656
    ds_read_b128 v[208:211], v248 offset:3200
    ds_read_b128 v[212:215], v248 offset:3216
    s_waitcnt lgkmcnt(14)
    v_mfma_f32_32x32x16_bf16 v[80:95], v[160:163], v[32:35], v[80:95]
    v_mfma_f32_32x32x16_bf16 v[96:111], v[164:167], v[32:35], v[96:111]
    v_mfma_f32_32x32x16_bf16 v[112:127], v[168:171], v[32:35], v[112:127]
    v_mfma_f32_32x32x16_bf16 v[128:143], v[172:175], v[32:35], v[128:143]
    v_mfma_f32_32x32x16_bf16 v[144:159], v[176:179], v[32:35], v[144:159]
    s_waitcnt lgkmcnt(14)
    v_lshlrev_b32 v234, 16, v36
    v_and_b32 v235, 0xffff0000, v36
    v_fma_f32 v234, v234, v246, v247
    v_fma_f32 v235, v235, v246, v247
    v_fma_f32 v234, v234, v216, v224
    v_fma_f32 v235, v235, v217, v225
    v_cvt_pk_bf16_f32 v36, v234, v235
    v_lshlrev_b32 v234, 16, v37
    v_and_b32 v235, 0xffff0000, v37
    v_fma_f32 v234, v234, v246, v247
    v_fma_f32 v235, v235, v246, v247
    v_fma_f32 v234, v234, v218, v226
    v_fma_f32 v235, v235, v219, v227
    v_cvt_pk_bf16_f32 v37, v234, v235
    v_lshlrev_b32 v234, 16, v38
    v_and_b32 v235, 0xffff0000, v38
    v_fma_f32 v234, v234, v246, v247
    v_fma_f32 v235, v235, v246, v247
    v_fma_f32 v234, v234, v220, v228
    v_fma_f32 v235, v235, v221, v229
    v_cvt_pk_bf16_f32 v38, v234, v235
    v_lshlrev_b32 v234, 16, v39
    v_and_b32 v235, 0xffff0000, v39
    v_fma_f32 v234, v234, v246, v247
    v_fma_f32 v235, v235, v246, v247
    v_fma_f32 v234, v234, v222, v230
    v_fma_f32 v235, v235, v223, v231
    v_cvt_pk_bf16_f32 v39, v234, v235
    s_nop 1
    ds_read_b64_tr_b16 v[160:161], v245 offset:10240
    ds_read_b64_tr_b16 v[162:163], v245 offset:11520
    ds_read_b64_tr_b16 v[164:165], v245 offset:10304
    ds_read_b64_tr_b16 v[166:167], v245 offset:11584
    ds_read_b64_tr_b16 v[168:169], v245 offset:10368
    ds_read_b64_tr_b16 v[170:171], v245 offset:11648
    ds_read_b64_tr_b16 v[172:173], v245 offset:10432
    ds_read_b64_tr_b16 v[174:175], v245 offset:11712
    ds_read_b64_tr_b16 v[176:177], v245 offset:10496
    ds_read_b64_tr_b16 v[178:179], v245 offset:11776
    ds_read_b128 v[216:219], v248 offset:704
    ds_read_b128 v[220:223], v248 offset:720
    ds_read_b128 v[224:227], v248 offset:3264
    ds_read_b128 v[228:231], v248 offset:3280
    s_waitcnt lgkmcnt(15)
    v_mfma_f32_32x32x16_bf16 v[80:95], v[180:183], v[36:39], v[80:95]
    v_mfma_f32_32x32x16_bf16 v[96:111], v[184:187], v[36:39], v[96:111]
    v_mfma_f32_32x32x16_bf16 v[112:127], v[188:191], v[36:39], v[112:127]
    v_mfma_f32_32x32x16_bf16 v[128:143], v[192:195], v[36:39], v[128:143]
    v_mfma_f32_32x32x16_bf16 v[144:159], v[196:199], v[36:39], v[144:159]
    s_waitcnt lgkmcnt(14)
    v_lshlrev_b32 v234, 16, v40
    v_and_b32 v235, 0xffff0000, v40
    v_fma_f32 v234, v234, v246, v247
    v_fma_f32 v235, v235, v246, v247
    v_fma_f32 v234, v234, v200, v208
    v_fma_f32 v235, v235, v201, v209
    v_cvt_pk_bf16_f32 v40, v234, v235
    v_lshlrev_b32 v234, 16, v41
    v_and_b32 v235, 0xffff0000, v41
    v_fma_f32 v234, v234, v246, v247
    v_fma_f32 v235, v235, v246, v247
    v_fma_f32 v234, v234, v202, v210
    v_fma_f32 v235, v235, v203, v211
    v_cvt_pk_bf16_f32 v41, v234, v235
    v_lshlrev_b32 v234, 16, v42
    v_and_b32 v235, 0xffff0000, v42
    v_fma_f32 v234, v234, v246, v247
    v_fma_f32 v235, v235, v246, v247
    v_fma_f32 v234, v234, v204, v212
    v_fma_f32 v235, v235, v205, v213
    v_cvt_pk_bf16_f32 v42, v234, v235
    v_lshlrev_b32 v234, 16, v43
    v_and_b32 v235, 0xffff0000, v43
    v_fma_f32 v234, v234, v246, v247
    v_fma_f32 v235, v235, v246, v247
    v_fma_f32 v234, v234, v206, v214
    v_fma_f32 v235, v235, v207, v215
    v_cvt_pk_bf16_f32 v43, v234, v235
    s_nop 1
    ds_read_b64_tr_b16 v[180:181], v245 offset:15360
    ds_read_b64_tr_b16 v[182:183], v245 offset:16640
    ds_read_b64_tr_b16 v[184:185], v245 offset:15424
    ds_read_b64_tr_b16 v[186:187], v245 offset:16704
    ds_read_b64_tr_b16 v[188:189], v245 offset:15488
    ds_read_b64_tr_b16 v[190:191], v245 offset:16768
    ds_read_b64_tr_b16 v[192:193], v245 offset:15552
    ds_read_b64_tr_b16 v[194:195], v245 offset:16832
    ds_read_b64_tr_b16 v[196:197], v245 offset:15616
    ds_read_b64_tr_b16 v[198:199], v245 offset:16896
    ds_read_b128 v[200:203], v248 offset:768
    ds_read_b128 v[204:207], v248 offset:784
    ds_read_b128 v[208:211], v248 offset:3328
    ds_read_b128 v[212:215], v248 offset:3344
    s_waitcnt lgkmcnt(15)
    v_mfma_f32_32x32x16_bf16 v[80:95], v[160:163], v[40:43], v[80:95]
    v_mfma_f32_32x32x16_bf16 v[96:111], v[164:167], v[40:43], v[96:111]
    v_mfma_f32_32x32x16_bf16 v[112:127], v[168:171], v[40:43], v[112:127]
    v_mfma_f32_32x32x16_bf16 v[128:143], v[172:175], v[40:43], v[128:143]
    v_mfma_f32_32x32x16_bf16 v[144:159], v[176:179], v[40:43], v[144:159]
    s_waitcnt lgkmcnt(14)
    v_lshlrev_b32 v234, 16, v44
    v_and_b32 v235, 0xffff0000, v44
    v_fma_f32 v234, v234, v246, v247
    v_fma_f32 v235, v235, v246, v247
    v_fma_f32 v234, v234, v216, v224
    v_fma_f32 v235, v235, v217, v225
    v_cvt_pk_bf16_f32 v44, v234, v235
    v_lshlrev_b32 v234, 16, v45
    v_and_b32 v235, 0xffff0000, v45
    v_fma_f32 v234, v234, v246, v247
    v_fma_f32 v235, v235, v246, v247
    v_fma_f32 v234, v234, v218, v226
    v_fma_f32 v235, v235, v219, v227
    v_cvt_pk_bf16_f32 v45, v234, v235
    v_lshlrev_b32 v234, 16, v46
    v_and_b32 v235, 0xffff0000, v46
    v_fma_f32 v234, v234, v246, v247
    v_fma_f32 v235, v235, v246, v247
    v_fma_f32 v234, v234, v220, v228
    v_fma_f32 v235, v235, v221, v229
    v_cvt_pk_bf16_f32 v46, v234, v235
    v_lshlrev_b32 v234, 16, v47
    v_and_b32 v235, 0xffff0000, v47
    v_fma_f32 v234, v234, v246, v247
    v_fma_f32 v235, v235, v246, v247
    v_fma_f32 v234, v234, v222, v230
    v_fma_f32 v235, v235, v223, v231
    v_cvt_pk_bf16_f32 v47, v234, v235
    s_nop 1
    ds_read_b128 v[216:219], v248 offset:832
    ds_read_b128 v[220:223], v248 offset:848
    ds_read_b128 v[224:227], v248 offset:3392
    ds_read_b128 v[228:231], v248 offset:3408
    s_waitcnt lgkmcnt(8)
    v_mfma_f32_32x32x16_bf16 v[80:95], v[180:183], v[44:47], v[80:95]
    v_mfma_f32_32x32x16_bf16 v[96:111], v[184:187], v[44:47], v[96:111]
    v_mfma_f32_32x32x16_bf16 v[112:127], v[188:191], v[44:47], v[112:127]
    v_mfma_f32_32x32x16_bf16 v[128:143], v[192:195], v[44:47], v[128:143]
    v_mfma_f32_32x32x16_bf16 v[144:159], v[196:199], v[44:47], v[144:159]
    s_waitcnt lgkmcnt(4)
    v_lshlrev_b32 v234, 16, v48
    v_and_b32 v235, 0xffff0000, v48
    v_fma_f32 v234, v234, v246, v247
    v_fma_f32 v235, v235, v246, v247
    v_fma_f32 v234, v234, v200, v208
    v_fma_f32 v235, v235, v201, v209
    v_cvt_pk_bf16_f32 v48, v234, v235
    v_lshlrev_b32 v234, 16, v49
    v_and_b32 v235, 0xffff0000, v49
    v_fma_f32 v234, v234, v246, v247
    v_fma_f32 v235, v235, v246, v247
    v_fma_f32 v234, v234, v202, v210
    v_fma_f32 v235, v235, v203, v211
    v_cvt_pk_bf16_f32 v49, v234, v235
    v_lshlrev_b32 v234, 16, v50
    v_and_b32 v235, 0xffff0000, v50
    v_fma_f32 v234, v234, v246, v247
    v_fma_f32 v235, v235, v246, v247
    v_fma_f32 v234, v234, v204, v212
    v_fma_f32 v235, v235, v205, v213
    v_cvt_pk_bf16_f32 v50, v234, v235
    v_lshlrev_b32 v234, 16, v51
    v_and_b32 v235, 0xffff0000, v51
    v_fma_f32 v234, v234, v246, v247
    v_fma_f32 v235, v235, v246, v247
    v_fma_f32 v234, v234, v206, v214
    v_fma_f32 v235, v235, v207, v215
    v_cvt_pk_bf16_f32 v51, v234, v235
    s_nop 1
    s_waitcnt vmcnt(5)
    s_barrier
    ds_read_b64_tr_b16 v[160:161], v243 offset:0
    ds_read_b64_tr_b16 v[162:163], v243 offset:1280
    ds_read_b64_tr_b16 v[164:165], v243 offset:64
    ds_read_b64_tr_b16 v[166:167], v243 offset:1344
    ds_read_b64_tr_b16 v[168:169], v243 offset:128
    ds_read_b64_tr_b16 v[170:171], v243 offset:1408
    ds_read_b64_tr_b16 v[172:173], v243 offset:192
    ds_read_b64_tr_b16 v[174:175], v243 offset:1472
    ds_read_b64_tr_b16 v[176:177], v243 offset:256
    ds_read_b64_tr_b16 v[178:179], v243 offset:1536
    ds_read_b64_tr_b16 v[180:181], v243 offset:5120
    ds_read_b64_tr_b16 v[182:183], v243 offset:6400
    ds_read_b64_tr_b16 v[184:185], v243 offset:5184
    ds_read_b64_tr_b16 v[186:187], v243 offset:6464
    ds_read_b64_tr_b16 v[188:189], v243 offset:5248
    ds_read_b64_tr_b16 v[190:191], v243 offset:6528
    ds_read_b64_tr_b16 v[192:193], v243 offset:5312
    ds_read_b64_tr_b16 v[194:195], v243 offset:6592
    ds_read_b64_tr_b16 v[196:197], v243 offset:5376
    ds_read_b64_tr_b16 v[198:199], v243 offset:6656
    ds_read_b128 v[200:203], v248 offset:896
    ds_read_b128 v[204:207], v248 offset:912
    ds_read_b128 v[208:211], v248 offset:3456
    ds_read_b128 v[212:215], v248 offset:3472
    s_waitcnt lgkmcnt(14)
    v_mfma_f32_32x32x16_bf16 v[80:95], v[160:163], v[48:51], v[80:95]
    v_mfma_f32_32x32x16_bf16 v[96:111], v[164:167], v[48:51], v[96:111]
    v_mfma_f32_32x32x16_bf16 v[112:127], v[168:171], v[48:51], v[112:127]
    v_mfma_f32_32x32x16_bf16 v[128:143], v[172:175], v[48:51], v[128:143]
    v_mfma_f32_32x32x16_bf16 v[144:159], v[176:179], v[48:51], v[144:159]
    s_waitcnt lgkmcnt(14)
    v_lshlrev_b32 v234, 16, v52
    v_and_b32 v235, 0xffff0000, v52
    v_fma_f32 v234, v234, v246, v247
    v_fma_f32 v235, v235, v246, v247
    v_fma_f32 v234, v234, v216, v224
    v_fma_f32 v235, v235, v217, v225
    v_cvt_pk_bf16_f32 v52, v234, v235
    v_lshlrev_b32 v234, 16, v53
    v_and_b32 v235, 0xffff0000, v53
    v_fma_f32 v234, v234, v246, v247
    v_fma_f32 v235, v235, v246, v247
    v_fma_f32 v234, v234, v218, v226
    v_fma_f32 v235, v235, v219, v227
    v_cvt_pk_bf16_f32 v53, v234, v235
    v_lshlrev_b32 v234, 16, v54
    v_and_b32 v235, 0xffff0000, v54
    v_fma_f32 v234, v234, v246, v247
    v_fma_f32 v235, v235, v246, v247
    v_fma_f32 v234, v234, v220, v228
    v_fma_f32 v235, v235, v221, v229
    v_cvt_pk_bf16_f32 v54, v234, v235
    v_lshlrev_b32 v234, 16, v55
    v_and_b32 v235, 0xffff0000, v55
    v_fma_f32 v234, v234, v246, v247
    v_fma_f32 v235, v235, v246, v247
    v_fma_f32 v234, v234, v222, v230
    v_fma_f32 v235, v235, v223, v231
    v_cvt_pk_bf16_f32 v55, v234, v235
    s_nop 1
    ds_read_b64_tr_b16 v[160:161], v243 offset:10240
    ds_read_b64_tr_b16 v[162:163], v243 offset:11520
    ds_read_b64_tr_b16 v[164:165], v243 offset:10304
    ds_read_b64_tr_b16 v[166:167], v243 offset:11584
    ds_read_b64_tr_b16 v[168:169], v243 offset:10368
    ds_read_b64_tr_b16 v[170:171], v243 offset:11648
    ds_read_b64_tr_b16 v[172:173], v243 offset:10432
    ds_read_b64_tr_b16 v[174:175], v243 offset:11712
    ds_read_b64_tr_b16 v[176:177], v243 offset:10496
    ds_read_b64_tr_b16 v[178:179], v243 offset:11776
    ds_read_b128 v[216:219], v248 offset:960
    ds_read_b128 v[220:223], v248 offset:976
    ds_read_b128 v[224:227], v248 offset:3520
    ds_read_b128 v[228:231], v248 offset:3536
    s_waitcnt lgkmcnt(15)
    v_mfma_f32_32x32x16_bf16 v[80:95], v[180:183], v[52:55], v[80:95]
    v_mfma_f32_32x32x16_bf16 v[96:111], v[184:187], v[52:55], v[96:111]
    v_mfma_f32_32x32x16_bf16 v[112:127], v[188:191], v[52:55], v[112:127]
    v_mfma_f32_32x32x16_bf16 v[128:143], v[192:195], v[52:55], v[128:143]
    v_mfma_f32_32x32x16_bf16 v[144:159], v[196:199], v[52:55], v[144:159]
    s_waitcnt lgkmcnt(14)
    v_lshlrev_b32 v234, 16, v56
    v_and_b32 v235, 0xffff0000, v56
    v_fma_f32 v234, v234, v246, v247
    v_fma_f32 v235, v235, v246, v247
    v_fma_f32 v234, v234, v200, v208
    v_fma_f32 v235, v235, v201, v209
    v_cvt_pk_bf16_f32 v56, v234, v235
    v_lshlrev_b32 v234, 16, v57
    v_and_b32 v235, 0xffff0000, v57
    v_fma_f32 v234, v234, v246, v247
    v_fma_f32 v235, v235, v246, v247
    v_fma_f32 v234, v234, v202, v210
    v_fma_f32 v235, v235, v203, v211
    v_cvt_pk_bf16_f32 v57, v234, v235
    v_lshlrev_b32 v234, 16, v58
    v_and_b32 v235, 0xffff0000, v58
    v_fma_f32 v234, v234, v246, v247
    v_fma_f32 v235, v235, v246, v247
    v_fma_f32 v234, v234, v204, v212
    v_fma_f32 v235, v235, v205, v213
    v_cvt_pk_bf16_f32 v58, v234, v235
    v_lshlrev_b32 v234, 16, v59
    v_and_b32 v235, 0xffff0000, v59
    v_fma_f32 v234, v234, v246, v247
    v_fma_f32 v235, v235, v246, v247
    v_fma_f32 v234, v234, v206, v214
    v_fma_f32 v235, v235, v207, v215
    v_cvt_pk_bf16_f32 v59, v234, v235
    s_nop 1
    ds_read_b64_tr_b16 v[180:181], v243 offset:15360
    ds_read_b64_tr_b16 v[182:183], v243 offset:16640
    ds_read_b64_tr_b16 v[184:185], v243 offset:15424
    ds_read_b64_tr_b16 v[186:187], v243 offset:16704
    ds_read_b64_tr_b16 v[188:189], v243 offset:15488
    ds_read_b64_tr_b16 v[190:191], v243 offset:16768
    ds_read_b64_tr_b16 v[192:193], v243 offset:15552
    ds_read_b64_tr_b16 v[194:195], v243 offset:16832
    ds_read_b64_tr_b16 v[196:197], v243 offset:15616
    ds_read_b64_tr_b16 v[198:199], v243 offset:16896
    ds_read_b128 v[200:203], v248 offset:1024
    ds_read_b128 v[204:207], v248 offset:1040
    ds_read_b128 v[208:211], v248 offset:3584
    ds_read_b128 v[212:215], v248 offset:3600
    s_waitcnt lgkmcnt(15)
    v_mfma_f32_32x32x16_bf16 v[80:95], v[160:163], v[56:59], v[80:95]
    v_mfma_f32_32x32x16_bf16 v[96:111], v[164:167], v[56:59], v[96:111]
    v_mfma_f32_32x32x16_bf16 v[112:127], v[168:171], v[56:59], v[112:127]
    v_mfma_f32_32x32x16_bf16 v[128:143], v[172:175], v[56:59], v[128:143]
    v_mfma_f32_32x32x16_bf16 v[144:159], v[176:179], v[56:59], v[144:159]
    s_waitcnt lgkmcnt(14)
    v_lshlrev_b32 v234, 16, v60
    v_and_b32 v235, 0xffff0000, v60
    v_fma_f32 v234, v234, v246, v247
    v_fma_f32 v235, v235, v246, v247
    v_fma_f32 v234, v234, v216, v224
    v_fma_f32 v235, v235, v217, v225
    v_cvt_pk_bf16_f32 v60, v234, v235
    v_lshlrev_b32 v234, 16, v61
    v_and_b32 v235, 0xffff0000, v61
    v_fma_f32 v234, v234, v246, v247
    v_fma_f32 v235, v235, v246, v247
    v_fma_f32 v234, v234, v218, v226
    v_fma_f32 v235, v235, v219, v227
    v_cvt_pk_bf16_f32 v61, v234, v235
    v_lshlrev_b32 v234, 16, v62
    v_and_b32 v235, 0xffff0000, v62
    v_fma_f32 v234, v234, v246, v247
    v_fma_f32 v235, v235, v246, v247
    v_fma_f32 v234, v234, v220, v228
    v_fma_f32 v235, v235, v221, v229
    v_cvt_pk_bf16_f32 v62, v234, v235
    v_lshlrev_b32 v234, 16, v63
    v_and_b32 v235, 0xffff0000, v63
    v_fma_f32 v234, v234, v246, v247
    v_fma_f32 v235, v235, v246, v247
    v_fma_f32 v234, v234, v222, v230
    v_fma_f32 v235, v235, v223, v231
    v_cvt_pk_bf16_f32 v63, v234, v235
    s_nop 1
    ds_read_b128 v[216:219], v248 offset:1088
    ds_read_b128 v[220:223], v248 offset:1104
    ds_read_b128 v[224:227], v248 offset:3648
    ds_read_b128 v[228:231], v248 offset:3664
    s_waitcnt lgkmcnt(8)
    v_mfma_f32_32x32x16_bf16 v[80:95], v[180:183], v[60:63], v[80:95]
    v_mfma_f32_32x32x16_bf16 v[96:111], v[184:187], v[60:63], v[96:111]
    v_mfma_f32_32x32x16_bf16 v[112:127], v[188:191], v[60:63], v[112:127]
    v_mfma_f32_32x32x16_bf16 v[128:143], v[192:195], v[60:63], v[128:143]
    v_mfma_f32_32x32x16_bf16 v[144:159], v[196:199], v[60:63], v[144:159]
    s_waitcnt lgkmcnt(4)
    v_lshlrev_b32 v234, 16, v64
    v_and_b32 v235, 0xffff0000, v64
    v_fma_f32 v234, v234, v246, v247
    v_fma_f32 v235, v235, v246, v247
    v_fma_f32 v234, v234, v200, v208
    v_fma_f32 v235, v235, v201, v209
    v_cvt_pk_bf16_f32 v64, v234, v235
    v_lshlrev_b32 v234, 16, v65
    v_and_b32 v235, 0xffff0000, v65
    v_fma_f32 v234, v234, v246, v247
    v_fma_f32 v235, v235, v246, v247
    v_fma_f32 v234, v234, v202, v210
    v_fma_f32 v235, v235, v203, v211
    v_cvt_pk_bf16_f32 v65, v234, v235
    v_lshlrev_b32 v234, 16, v66
    v_and_b32 v235, 0xffff0000, v66
    v_fma_f32 v234, v234, v246, v247
    v_fma_f32 v235, v235, v246, v247
    v_fma_f32 v234, v234, v204, v212
    v_fma_f32 v235, v235, v205, v213
    v_cvt_pk_bf16_f32 v66, v234, v235
    v_lshlrev_b32 v234, 16, v67
    v_and_b32 v235, 0xffff0000, v67
    v_fma_f32 v234, v234, v246, v247
    v_fma_f32 v235, v235, v246, v247
    v_fma_f32 v234, v234, v206, v214
    v_fma_f32 v235, v235, v207, v215
    v_cvt_pk_bf16_f32 v67, v234, v235
    s_nop 1
    s_waitcnt vmcnt(0)
    s_barrier
    ds_read_b64_tr_b16 v[160:161], v244 offset:0
    ds_read_b64_tr_b16 v[162:163], v244 offset:1280
    ds_read_b64_tr_b16 v[164:165], v244 offset:64
    ds_read_b64_tr_b16 v[166:167], v244 offset:1344
    ds_read_b64_tr_b16 v[168:169], v244 offset:128
    ds_read_b64_tr_b16 v[170:171], v244 offset:1408
    ds_read_b64_tr_b16 v[172:173], v244 offset:192
    ds_read_b64_tr_b16 v[174:175], v244 offset:1472
    ds_read_b64_tr_b16 v[176:177], v244 offset:256
    ds_read_b64_tr_b16 v[178:179], v244 offset:1536
    ds_read_b64_tr_b16 v[180:181], v244 offset:5120
    ds_read_b64_tr_b16 v[182:183], v244 offset:6400
    ds_read_b64_tr_b16 v[184:185], v244 offset:5184
    ds_read_b64_tr_b16 v[186:187], v244 offset:6464
    ds_read_b64_tr_b16 v[188:189], v244 offset:5248
    ds_read_b64_tr_b16 v[190:191], v244 offset:6528
    ds_read_b64_tr_b16 v[192:193], v244 offset:5312
    ds_read_b64_tr_b16 v[194:195], v244 offset:6592
    ds_read_b64_tr_b16 v[196:197], v244 offset:5376
    ds_read_b64_tr_b16 v[198:199], v244 offset:6656
    ds_read_b128 v[200:203], v248 offset:1152
    ds_read_b128 v[204:207], v248 offset:1168
    ds_read_b128 v[208:211], v248 offset:3712
    ds_read_b128 v[212:215], v248 offset:3728
    s_waitcnt lgkmcnt(14)
    v_mfma_f32_32x32x16_bf16 v[80:95], v[160:163], v[64:67], v[80:95]
    v_mfma_f32_32x32x16_bf16 v[96:111], v[164:167], v[64:67], v[96:111]
    v_mfma_f32_32x32x16_bf16 v[112:127], v[168:171], v[64:67], v[112:127]
    v_mfma_f32_32x32x16_bf16 v[128:143], v[172:175], v[64:67], v[128:143]
    v_mfma_f32_32x32x16_bf16 v[144:159], v[176:179], v[64:67], v[144:159]
    s_waitcnt lgkmcnt(14)
    v_lshlrev_b32 v234, 16, v68
    v_and_b32 v235, 0xffff0000, v68
    v_fma_f32 v234, v234, v246, v247
    v_fma_f32 v235, v235, v246, v247
    v_fma_f32 v234, v234, v216, v224
    v_fma_f32 v235, v235, v217, v225
    v_cvt_pk_bf16_f32 v68, v234, v235
    v_lshlrev_b32 v234, 16, v69
    v_and_b32 v235, 0xffff0000, v69
    v_fma_f32 v234, v234, v246, v247
    v_fma_f32 v235, v235, v246, v247
    v_fma_f32 v234, v234, v218, v226
    v_fma_f32 v235, v235, v219, v227
    v_cvt_pk_bf16_f32 v69, v234, v235
    v_lshlrev_b32 v234, 16, v70
    v_and_b32 v235, 0xffff0000, v70
    v_fma_f32 v234, v234, v246, v247
    v_fma_f32 v235, v235, v246, v247
    v_fma_f32 v234, v234, v220, v228
    v_fma_f32 v235, v235, v221, v229
    v_cvt_pk_bf16_f32 v70, v234, v235
    v_lshlrev_b32 v234, 16, v71
    v_and_b32 v235, 0xffff0000, v71
    v_fma_f32 v234, v234, v246, v247
    v_fma_f32 v235, v235, v246, v247
    v_fma_f32 v234, v234, v222, v230
    v_fma_f32 v235, v235, v223, v231
    v_cvt_pk_bf16_f32 v71, v234, v235
    s_nop 1
    ds_read_b64_tr_b16 v[160:161], v244 offset:10240
    ds_read_b64_tr_b16 v[162:163], v244 offset:11520
    ds_read_b64_tr_b16 v[164:165], v244 offset:10304
    ds_read_b64_tr_b16 v[166:167], v244 offset:11584
    ds_read_b64_tr_b16 v[168:169], v244 offset:10368
    ds_read_b64_tr_b16 v[170:171], v244 offset:11648
    ds_read_b64_tr_b16 v[172:173], v244 offset:10432
    ds_read_b64_tr_b16 v[174:175], v244 offset:11712
    ds_read_b64_tr_b16 v[176:177], v244 offset:10496
    ds_read_b64_tr_b16 v[178:179], v244 offset:11776
    ds_read_b128 v[216:219], v248 offset:1216
    ds_read_b128 v[220:223], v248 offset:1232
    ds_read_b128 v[224:227], v248 offset:3776
    ds_read_b128 v[228:231], v248 offset:3792
    s_waitcnt lgkmcnt(15)
    v_mfma_f32_32x32x16_bf16 v[80:95], v[180:183], v[68:71], v[80:95]
    v_mfma_f32_32x32x16_bf16 v[96:111], v[184:187], v[68:71], v[96:111]
    v_mfma_f32_32x32x16_bf16 v[112:127], v[188:191], v[68:71], v[112:127]
    v_mfma_f32_32x32x16_bf16 v[128:143], v[192:195], v[68:71], v[128:143]
    v_mfma_f32_32x32x16_bf16 v[144:159], v[196:199], v[68:71], v[144:159]
    s_waitcnt lgkmcnt(14)
    v_lshlrev_b32 v234, 16, v72
    v_and_b32 v235, 0xffff0000, v72
    v_fma_f32 v234, v234, v246, v247
    v_fma_f32 v235, v235, v246, v247
    v_fma_f32 v234, v234, v200, v208
    v_fma_f32 v235, v235, v201, v209
    v_cvt_pk_bf16_f32 v72, v234, v235
    v_lshlrev_b32 v234, 16, v73
    v_and_b32 v235, 0xffff0000, v73
    v_fma_f32 v234, v234, v246, v247
    v_fma_f32 v235, v235, v246, v247
    v_fma_f32 v234, v234, v202, v210
    v_fma_f32 v235, v235, v203, v211
    v_cvt_pk_bf16_f32 v73, v234, v235
    v_lshlrev_b32 v234, 16, v74
    v_and_b32 v235, 0xffff0000, v74
    v_fma_f32 v234, v234, v246, v247
    v_fma_f32 v235, v235, v246, v247
    v_fma_f32 v234, v234, v204, v212
    v_fma_f32 v235, v235, v205, v213
    v_cvt_pk_bf16_f32 v74, v234, v235
    v_lshlrev_b32 v234, 16, v75
    v_and_b32 v235, 0xffff0000, v75
    v_fma_f32 v234, v234, v246, v247
    v_fma_f32 v235, v235, v246, v247
    v_fma_f32 v234, v234, v206, v214
    v_fma_f32 v235, v235, v207, v215
    v_cvt_pk_bf16_f32 v75, v234, v235
    s_nop 1
    ds_read_b64_tr_b16 v[180:181], v244 offset:15360
    ds_read_b64_tr_b16 v[182:183], v244 offset:16640
    ds_read_b64_tr_b16 v[184:185], v244 offset:15424
    ds_read_b64_tr_b16 v[186:187], v244 offset:16704
    ds_read_b64_tr_b16 v[188:189], v244 offset:15488
    ds_read_b64_tr_b16 v[190:191], v244 offset:16768
    ds_read_b64_tr_b16 v[192:193], v244 offset:15552
    ds_read_b64_tr_b16 v[194:195], v244 offset:16832
    ds_read_b64_tr_b16 v[196:197], v244 offset:15616
    ds_read_b64_tr_b16 v[198:199], v244 offset:16896
    s_waitcnt lgkmcnt(14)
    v_mfma_f32_32x32x16_bf16 v[80:95], v[160:163], v[72:75], v[80:95]
    v_mfma_f32_32x32x16_bf16 v[96:111], v[164:167], v[72:75], v[96:111]
    v_mfma_f32_32x32x16_bf16 v[112:127], v[168:171], v[72:75], v[112:127]
    v_mfma_f32_32x32x16_bf16 v[128:143], v[172:175], v[72:75], v[128:143]
    v_mfma_f32_32x32x16_bf16 v[144:159], v[176:179], v[72:75], v[144:159]
    s_waitcnt lgkmcnt(10)
    v_lshlrev_b32 v234, 16, v76
    v_and_b32 v235, 0xffff0000, v76
    v_fma_f32 v234, v234, v246, v247
    v_fma_f32 v235, v235, v246, v247
    v_fma_f32 v234, v234, v216, v224
    v_fma_f32 v235, v235, v217, v225
    v_cvt_pk_bf16_f32 v76, v234, v235
    v_lshlrev_b32 v234, 16, v77
    v_and_b32 v235, 0xffff0000, v77
    v_fma_f32 v234, v234, v246, v247
    v_fma_f32 v235, v235, v246, v247
    v_fma_f32 v234, v234, v218, v226
    v_fma_f32 v235, v235, v219, v227
    v_cvt_pk_bf16_f32 v77, v234, v235
    v_lshlrev_b32 v234, 16, v78
    v_and_b32 v235, 0xffff0000, v78
    v_fma_f32 v234, v234, v246, v247
    v_fma_f32 v235, v235, v246, v247
    v_fma_f32 v234, v234, v220, v228
    v_fma_f32 v235, v235, v221, v229
    v_cvt_pk_bf16_f32 v78, v234, v235
    v_lshlrev_b32 v234, 16, v79
    v_and_b32 v235, 0xffff0000, v79
    v_fma_f32 v234, v234, v246, v247
    v_fma_f32 v235, v235, v246, v247
    v_fma_f32 v234, v234, v222, v230
    v_fma_f32 v235, v235, v223, v231
    v_cvt_pk_bf16_f32 v79, v234, v235
    s_nop 1
    s_waitcnt lgkmcnt(0)
    v_mfma_f32_32x32x16_bf16 v[80:95], v[180:183], v[76:79], v[80:95]
    v_mfma_f32_32x32x16_bf16 v[96:111], v[184:187], v[76:79], v[96:111]
    v_mfma_f32_32x32x16_bf16 v[112:127], v[188:191], v[76:79], v[112:127]
    v_mfma_f32_32x32x16_bf16 v[128:143], v[192:195], v[76:79], v[128:143]
    v_mfma_f32_32x32x16_bf16 v[144:159], v[196:199], v[76:79], v[144:159]
    s_waitcnt lgkmcnt(0)
    s_nop 15
    s_nop 3
    s_barrier
    v_lshlrev_b32 v250, 4, v232
    s_mul_i32 s29, s28, 20480
    s_add_u32 s29, s29, 9216
    v_add_u32 v250, s29, v250
    v_and_b32 v234, 31, v232
    v_mul_u32_u24 v234, 208, v234
    v_lshl_add_u32 v234, v233, 3, v234
    s_mul_i32 s29, s26, 6656
    s_add_u32 s29, s29, 91136
    v_add_u32 v234, s29, v234
    s_lshl_b32 s30, s24, 7
    s_lshl_b32 s45, s28, 5
    s_add_u32 s30, s30, s45
    s_mul_i32 s30, s30, 1280
    s_mul_i32 s45, s25, 320
    s_add_u32 s30, s30, s45
    s_cmp_eq_u32 s27, 0
    s_cbranch_scc1 L_ep_lo
    ds_write_b128 v250, v[80:83] offset:0
    ds_write_b128 v250, v[84:87] offset:1024
    ds_write_b128 v250, v[88:91] offset:2048
    ds_write_b128 v250, v[92:95] offset:3072
    ds_write_b128 v250, v[96:99] offset:4096
    ds_write_b128 v250, v[100:103] offset:5120
    ds_write_b128 v250, v[104:107] offset:6144
    ds_write_b128 v250, v[108:111] offset:7168
    ds_write_b128 v250, v[112:115] offset:8192
    ds_write_b128 v250, v[116:119] offset:9216
    ds_write_b128 v250, v[120:123] offset:10240
    ds_write_b128 v250, v[124:127] offset:11264
    s_waitcnt lgkmcnt(0)
    s_barrier
    ds_read_b128 v[160:163], v250 offset:12288
    ds_read_b128 v[164:167], v250 offset:13312
    ds_read_b128 v[168:171], v250 offset:14336
    ds_read_b128 v[172:175], v250 offset:15360
    s_waitcnt lgkmcnt(0)
    v_add_f32 v128, v128, v160
    v_add_f32 v129, v129, v161
    v_add_f32 v130, v130, v162
    v_add_f32 v131, v131, v163
    v_cvt_pk_bf16_f32 v180, v128, v129
    v_cvt_pk_bf16_f32 v181, v130, v131
    ds_write_b64 v234, v[180:181] offset:0
    v_add_f32 v132, v132, v164
    v_add_f32 v133, v133, v165
    v_add_f32 v134, v134, v166
    v_add_f32 v135, v135, v167
    v_cvt_pk_bf16_f32 v182, v132, v133
    v_cvt_pk_bf16_f32 v183, v134, v135
    ds_write_b64 v234, v[182:183] offset:16
    v_add_f32 v136, v136, v168
    v_add_f32 v137, v137, v169
    v_add_f32 v138, v138, v170
    v_add_f32 v139, v139, v171
    v_cvt_pk_bf16_f32 v184, v136, v137
    v_cvt_pk_bf16_f32 v185, v138, v139
    ds_write_b64 v234, v[184:185] offset:32
    v_add_f32 v140, v140, v172
    v_add_f32 v141, v141, v173
    v_add_f32 v142, v142, v174
    v_add_f32 v143, v143, v175
    v_cvt_pk_bf16_f32 v186, v140, v141
    v_cvt_pk_bf16_f32 v187, v142, v143
    ds_write_b64 v234, v[186:187] offset:48
    ds_read_b128 v[160:163], v250 offset:16384
    ds_read_b128 v[164:167], v250 offset:17408
    ds_read_b128 v[168:171], v250 offset:18432
    ds_read_b128 v[172:175], v250 offset:19456
    s_waitcnt lgkmcnt(0)
    v_add_f32 v144, v144, v160
    v_add_f32 v145, v145, v161
    v_add_f32 v146, v146, v162
    v_add_f32 v147, v147, v163
    v_cvt_pk_bf16_f32 v180, v144, v145
    v_cvt_pk_bf16_f32 v181, v146, v147
    ds_write_b64 v234, v[180:181] offset:64
    v_add_f32 v148, v148, v164
    v_add_f32 v149, v149, v165
    v_add_f32 v150, v150, v166
    v_add_f32 v151, v151, v167
    v_cvt_pk_bf16_f32 v182, v148, v149
    v_cvt_pk_bf16_f32 v183, v150, v151
    ds_write_b64 v234, v[182:183] offset:80
    v_add_f32 v152, v152, v168
    v_add_f32 v153, v153, v169
    v_add_f32 v154, v154, v170
    v_add_f32 v155, v155, v171
    v_cvt_pk_bf16_f32 v184, v152, v153
    v_cvt_pk_bf16_f32 v185, v154, v155
    ds_write_b64 v234, v[184:185] offset:96
    v_add_f32 v156, v156, v172
    v_add_f32 v157, v157, v173
    v_add_f32 v158, v158, v174
    v_add_f32 v159, v159, v175
    v_cvt_pk_bf16_f32 v186, v156, v157
    v_cvt_pk_bf16_f32 v187, v158, v159
    ds_write_b64 v234, v[186:187] offset:112
    s_waitcnt lgkmcnt(0)
    s_mov_b32 s44, 8192
    v_add_u32 v235, 0, v232
    v_mul_lo_u32 v236, v235, s44
    v_lshrrev_b32 v236, 16, v236
    v_mul_u32_u24 v237, 8, v236
    v_sub_u32 v235, v235, v237
    v_mul_u32_u24 v237, 208, v236
    v_lshl_add_u32 v237, v235, 4, v237
    v_add_u32 v237, s29, v237
    ds_read_b128 v[0:3], v237
    v_mul_u32_u24 v237, 1280, v236
    v_lshl_add_u32 v40, v235, 4, v237
    v_add_u32 v235, 64, v232
    v_mul_lo_u32 v236, v235, s44
    v_lshrrev_b32 v236, 16, v236
    v_mul_u32_u24 v237, 8, v236
    v_sub_u32 v235, v235, v237
    v_mul_u32_u24 v237, 208, v236
    v_lshl_add_u32 v237, v235, 4, v237
    v_add_u32 v237, s29, v237
    ds_read_b128 v[4:7], v237
    v_mul_u32_u24 v237, 1280, v236
    v_lshl_add_u32 v41, v235, 4, v237
    v_add_u32 v235, 128, v232
    v_mul_lo_u32 v236, v235, s44
    v_lshrrev_b32 v236, 16, v236
    v_mul_u32_u24 v237, 8, v236
    v_sub_u32 v235, v235, v237
    v_mul_u32_u24 v237, 208, v236
    v_lshl_add_u32 v237, v235, 4, v237
    v_add_u32 v237, s29, v237
    ds_read_b128 v[8:11], v237
    v_mul_u32_u24 v237, 1280, v236
    v_lshl_add_u32 v42, v235, 4, v237
    v_add_u32 v235, 192, v232
    v_mul_lo_u32 v236, v235, s44
    v_lshrrev_b32 v236, 16, v236
    v_mul_u32_u24 v237, 8, v236
    v_sub_u32 v235, v235, v237
    v_mul_u32_u24 v237, 208, v236
    v_lshl_add_u32 v237, v235, 4, v237
    v_add_u32 v237, s29, v237
    ds_read_b128 v[12:15], v237
    v_mul_u32_u24 v237, 1280, v236
    v_lshl_add_u32 v43, v235, 4, v237
    s_waitcnt lgkmcnt(0)
    buffer_store_dwordx4 v[0:3], v40, s[12:15], s30 offen offset:192 nt
    buffer_store_dwordx4 v[4:7], v41, s[12:15], s30 offen offset:192 nt
    buffer_store_dwordx4 v[8:11], v42, s[12:15], s30 offen offset:192 nt
    buffer_store_dwordx4 v[12:15], v43, s[12:15], s30 offen offset:192 nt
    s_branch L_end
L_ep_lo:
    ds_write_b128 v250, v[128:131] offset:12288
    ds_write_b128 v250, v[132:135] offset:13312
    ds_write_b128 v250, v[136:139] offset:14336
    ds_write_b128 v250, v[140:143] offset:15360
    ds_write_b128 v250, v[144:147] offset:16384
    ds_write_b128 v250, v[148:151] offset:17408
    ds_write_b128 v250, v[152:155] offset:18432
    ds_write_b128 v250, v[156:159] offset:19456
    s_waitcnt lgkmcnt(0)
    s_barrier
    ds_read_b128 v[160:163], v250 offset:0
    ds_read_b128 v[164:167], v250 offset:1024
    ds_read_b128 v[168:171], v250 offset:2048
    ds_read_b128 v[172:175], v250 offset:3072
    s_waitcnt lgkmcnt(0)
    v_add_f32 v80, v80, v160
    v_add_f32 v81, v81, v161
    v_add_f32 v82, v82, v162
    v_add_f32 v83, v83, v163
    v_cvt_pk_bf16_f32 v180, v80, v81
    v_cvt_pk_bf16_f32 v181, v82, v83
    ds_write_b64 v234, v[180:181] offset:0
    v_add_f32 v84, v84, v164
    v_add_f32 v85, v85, v165
    v_add_f32 v86, v86, v166
    v_add_f32 v87, v87, v167
    v_cvt_pk_bf16_f32 v182, v84, v85
    v_cvt_pk_bf16_f32 v183, v86, v87
    ds_write_b64 v234, v[182:183] offset:16
    v_add_f32 v88, v88, v168
    v_add_f32 v89, v89, v169
    v_add_f32 v90, v90, v170
    v_add_f32 v91, v91, v171
    v_cvt_pk_bf16_f32 v184, v88, v89
    v_cvt_pk_bf16_f32 v185, v90, v91
    ds_write_b64 v234, v[184:185] offset:32
    v_add_f32 v92, v92, v172
    v_add_f32 v93, v93, v173
    v_add_f32 v94, v94, v174
    v_add_f32 v95, v95, v175
    v_cvt_pk_bf16_f32 v186, v92, v93
    v_cvt_pk_bf16_f32 v187, v94, v95
    ds_write_b64 v234, v[186:187] offset:48
    ds_read_b128 v[160:163], v250 offset:4096
    ds_read_b128 v[164:167], v250 offset:5120
    ds_read_b128 v[168:171], v250 offset:6144
    ds_read_b128 v[172:175], v250 offset:7168
    s_waitcnt lgkmcnt(0)
    v_add_f32 v96, v96, v160
    v_add_f32 v97, v97, v161
    v_add_f32 v98, v98, v162
    v_add_f32 v99, v99, v163
    v_cvt_pk_bf16_f32 v180, v96, v97
    v_cvt_pk_bf16_f32 v181, v98, v99
    ds_write_b64 v234, v[180:181] offset:64
    v_add_f32 v100, v100, v164
    v_add_f32 v101, v101, v165
    v_add_f32 v102, v102, v166
    v_add_f32 v103, v103, v167
    v_cvt_pk_bf16_f32 v182, v100, v101
    v_cvt_pk_bf16_f32 v183, v102, v103
    ds_write_b64 v234, v[182:183] offset:80
    v_add_f32 v104, v104, v168
    v_add_f32 v105, v105, v169
    v_add_f32 v106, v106, v170
    v_add_f32 v107, v107, v171
    v_cvt_pk_bf16_f32 v184, v104, v105
    v_cvt_pk_bf16_f32 v185, v106, v107
    ds_write_b64 v234, v[184:185] offset:96
    v_add_f32 v108, v108, v172
    v_add_f32 v109, v109, v173
    v_add_f32 v110, v110, v174
    v_add_f32 v111, v111, v175
    v_cvt_pk_bf16_f32 v186, v108, v109
    v_cvt_pk_bf16_f32 v187, v110, v111
    ds_write_b64 v234, v[186:187] offset:112
    ds_read_b128 v[160:163], v250 offset:8192
    ds_read_b128 v[164:167], v250 offset:9216
    ds_read_b128 v[168:171], v250 offset:10240
    ds_read_b128 v[172:175], v250 offset:11264
    s_waitcnt lgkmcnt(0)
    v_add_f32 v112, v112, v160
    v_add_f32 v113, v113, v161
    v_add_f32 v114, v114, v162
    v_add_f32 v115, v115, v163
    v_cvt_pk_bf16_f32 v180, v112, v113
    v_cvt_pk_bf16_f32 v181, v114, v115
    ds_write_b64 v234, v[180:181] offset:128
    v_add_f32 v116, v116, v164
    v_add_f32 v117, v117, v165
    v_add_f32 v118, v118, v166
    v_add_f32 v119, v119, v167
    v_cvt_pk_bf16_f32 v182, v116, v117
    v_cvt_pk_bf16_f32 v183, v118, v119
    ds_write_b64 v234, v[182:183] offset:144
    v_add_f32 v120, v120, v168
    v_add_f32 v121, v121, v169
    v_add_f32 v122, v122, v170
    v_add_f32 v123, v123, v171
    v_cvt_pk_bf16_f32 v184, v120, v121
    v_cvt_pk_bf16_f32 v185, v122, v123
    ds_write_b64 v234, v[184:185] offset:160
    v_add_f32 v124, v124, v172
    v_add_f32 v125, v125, v173
    v_add_f32 v126, v126, v174
    v_add_f32 v127, v127, v175
    v_cvt_pk_bf16_f32 v186, v124, v125
    v_cvt_pk_bf16_f32 v187, v126, v127
    ds_write_b64 v234, v[186:187] offset:176
    s_waitcnt lgkmcnt(0)
    s_mov_b32 s44, 5462
    v_add_u32 v235, 0, v232
    v_mul_lo_u32 v236, v235, s44
    v_lshrrev_b32 v236, 16, v236
    v_mul_u32_u24 v237, 12, v236
    v_sub_u32 v235, v235, v237
    v_mul_u32_u24 v237, 208, v236
    v_lshl_add_u32 v237, v235, 4, v237
    v_add_u32 v237, s29, v237
    ds_read_b128 v[0:3], v237
    v_mul_u32_u24 v237, 1280, v236
    v_lshl_add_u32 v40, v235, 4, v237
    v_add_u32 v235, 64, v232
    v_mul_lo_u32 v236, v235, s44
    v_lshrrev_b32 v236, 16, v236
    v_mul_u32_u24 v237, 12, v236
    v_sub_u32 v235, v235, v237
    v_mul_u32_u24 v237, 208, v236
    v_lshl_add_u32 v237, v235, 4, v237
    v_add_u32 v237, s29, v237
    ds_read_b128 v[4:7], v237
    v_mul_u32_u24 v237, 1280, v236
    v_lshl_add_u32 v41, v235, 4, v237
    v_add_u32 v235, 128, v232
    v_mul_lo_u32 v236, v235, s44
    v_lshrrev_b32 v236, 16, v236
    v_mul_u32_u24 v237, 12, v236
    v_sub_u32 v235, v235, v237
    v_mul_u32_u24 v237, 208, v236
    v_lshl_add_u32 v237, v235, 4, v237
    v_add_u32 v237, s29, v237
    ds_read_b128 v[8:11], v237
    v_mul_u32_u24 v237, 1280, v236
    v_lshl_add_u32 v42, v235, 4, v237
    v_add_u32 v235, 192, v232
    v_mul_lo_u32 v236, v235, s44
    v_lshrrev_b32 v236, 16, v236
    v_mul_u32_u24 v237, 12, v236
    v_sub_u32 v235, v235, v237
    v_mul_u32_u24 v237, 208, v236
    v_lshl_add_u32 v237, v235, 4, v237
    v_add_u32 v237, s29, v237
    ds_read_b128 v[12:15], v237
    v_mul_u32_u24 v237, 1280, v236
    v_lshl_add_u32 v43, v235, 4, v237
    v_add_u32 v235, 256, v232
    v_mul_lo_u32 v236, v235, s44
    v_lshrrev_b32 v236, 16, v236
    v_mul_u32_u24 v237, 12, v236
    v_sub_u32 v235, v235, v237
    v_mul_u32_u24 v237, 208, v236
    v_lshl_add_u32 v237, v235, 4, v237
    v_add_u32 v237, s29, v237
    ds_read_b128 v[16:19], v237
    v_mul_u32_u24 v237, 1280, v236
    v_lshl_add_u32 v44, v235, 4, v237
    v_add_u32 v235, 320, v232
    v_mul_lo_u32 v236, v235, s44
    v_lshrrev_b32 v236, 16, v236
    v_mul_u32_u24 v237, 12, v236
    v_sub_u32 v235, v235, v237
    v_mul_u32_u24 v237, 208, v236
    v_lshl_add_u32 v237, v235, 4, v237
    v_add_u32 v237, s29, v237
    ds_read_b128 v[20:23], v237
    v_mul_u32_u24 v237, 1280, v236
    v_lshl_add_u32 v45, v235, 4, v237
    s_waitcnt lgkmcnt(0)
    buffer_store_dwordx4 v[0:3], v40, s[12:15], s30 offen offset:0 nt
    buffer_store_dwordx4 v[4:7], v41, s[12:15], s30 offen offset:0 nt
    buffer_store_dwordx4 v[8:11], v42, s[12:15], s30 offen offset:0 nt
    buffer_store_dwordx4 v[12:15], v43, s[12:15], s30 offen offset:0 nt
    buffer_store_dwordx4 v[16:19], v44, s[12:15], s30 offen offset:0 nt
    buffer_store_dwordx4 v[20:23], v45, s[12:15], s30 offen offset:0 nt
L_end:
    s_endpgm
.section .rodata,"a"
.p2align 6
.amdhsa_kernel standalone__layernorm_linear__sampling_kernel
  .amdhsa_next_free_vgpr 256
  .amdhsa_next_free_sgpr 64
  .amdhsa_accum_offset 256
  .amdhsa_group_segment_fixed_size 0
  .amdhsa_kernarg_size 56
  .amdhsa_user_sgpr_count 2
  .amdhsa_user_sgpr_kernarg_segment_ptr 1
  .amdhsa_system_sgpr_workgroup_id_x 1
.end_amdhsa_kernel
```
